```python
import torch

def _softmax(x, axis=-1):
    return torch.softmax(x, dim=axis)
def _gelu(x):
    return torch.nn.functional.gelu(x, approximate="tanh")
def _silu(x):
    return torch.nn.functional.silu(x)
def _sigmoid(x):
    return torch.sigmoid(x)
def _layernorm(x, axis=-1, eps=1e-5):
    m = x.mean(dim=axis, keepdim=True)
    v = x.var(dim=axis, keepdim=True, unbiased=False)
    return (x - m) / torch.sqrt(v + eps)
def _scatter_add(tgt, idx, src, axis=0):
    return tgt.clone().index_add_(axis, idx, src)
def _segment_sum(src, seg, n):
    out = torch.zeros((n,) + src.shape[1:], dtype=src.dtype)
    return out.index_add_(0, seg, src)
def _pad(x, pw):
    flat = tuple(v for pair in reversed(pw) for v in pair)
    return torch.nn.functional.pad(x, flat)

kernel_name = 'gated_mix__spectral_fnet__mha_block__prompt'

def setup_inputs():

    _w = (lambda a: (lambda t: t.to(torch.bfloat16) if t.is_floating_point() else t)(torch.as_tensor(a)))
    def _A_setup():
        B, S, D = 1, 2048, 512
        ns = torch.arange(S)[:, None] * torch.arange(S)[None, :]
        nd = torch.arange(D)[:, None] * torch.arange(D)[None, :]
        Ws_re = torch.cos(-2.0 * torch.pi * ns / S).to(float)
        Ws_im = torch.sin(-2.0 * torch.pi * ns / S).to(float)
        Wd_re = torch.cos(-2.0 * torch.pi * nd / D).to(float)
        Wd_im = torch.sin(-2.0 * torch.pi * nd / D).to(float)
        return {
            "x": _w((lambda *s: torch.randn(*s, dtype=torch.bfloat16) * 0.05)(B, S, D)),
            "dft_seq_re": _w(Ws_re),
            "dft_seq_im": _w(Ws_im),
            "dft_hid_re": _w(Wd_re),
            "dft_hid_im": _w(Wd_im),
        }
    _A_in = _A_setup()

    def _B_setup():
        B, S, D, H = 1, 2048, 512, 32
        return {
            "x": _w((lambda *s: torch.randn(*s, dtype=torch.bfloat16) * 0.05)(B, S, D)),
            "wqkv": _w((lambda *s: torch.randn(*s, dtype=torch.bfloat16) * 1.6)(D, 3 * D)),
            "wo": _w((lambda *s: torch.randn(*s, dtype=torch.bfloat16) * 1.6)(D, D)),
        }
    _B_in = _B_setup()

    return {
        "A_x": _A_in["x"],
        "A_dft_seq_re": _A_in["dft_seq_re"],
        "A_dft_seq_im": _A_in["dft_seq_im"],
        "A_dft_hid_re": _A_in["dft_hid_re"],
        "A_dft_hid_im": _A_in["dft_hid_im"],
        "B_x": _B_in["x"],
        "B_wqkv": _B_in["wqkv"],
        "B_wo": _B_in["wo"],
        "gate_w": _w((lambda *s: torch.randn(*s, dtype=torch.bfloat16) * 0.05)(512) * 16.0),
    }

def reference(A_x, A_dft_seq_re, A_dft_seq_im, A_dft_hid_re, A_dft_hid_im, B_x, B_wqkv, B_wo, gate_w):
    def _A_ref(x, dft_seq_re, dft_seq_im, dft_hid_re, dft_hid_im):
        a = torch.einsum("bsd,ed->bse", x, dft_hid_re)
        b = torch.einsum("bsd,ed->bse", x, dft_hid_im)
        y = torch.einsum("ts,bse->bte", dft_seq_re, a) - torch.einsum("ts,bse->bte", dft_seq_im, b)
        return y

    def _B_ref(x, wqkv, wo):
        B, S, D = x.shape
        H = 32
        Dh = D // H
        qkv = (lambda x, *d: x.permute(*d))((x @ wqkv).reshape(B, S, 3, H, Dh), 2, 0, 3, 1, 4)
        q, k, v = qkv[0], qkv[1], qkv[2]
        scores = torch.einsum("bhqd,bhkd->bhqk", q, k) * (Dh ** -0.5)
        p = _softmax(scores, axis=-1)
        o = torch.einsum("bhqk,bhkd->bhqd", p, v)
        return (lambda x, *d: x.permute(*d))(o, 0, 2, 1, 3).reshape(B, S, D) @ wo

    x = A_x
    g = _sigmoid((x * gate_w).sum(-1, keepdims=True))
    a = _A_ref(x, A_dft_seq_re, A_dft_seq_im, A_dft_hid_re, A_dft_hid_im)
    b = _B_ref(x, B_wqkv, B_wo)
    return g * a + (1 - g) * b
```

```asm
; @launch kernel=k1_qkv_kernel grid=(256,1,1) block=(512,1,1) lds=163840
; @launch kernel=k2_attn_kernel grid=(256,1,1) block=(768,1,1) lds=147520
.amdgcn_target "amdgcn-amd-amdhsa--gfx950"
.text
.globl k1_qkv_kernel
.p2align 8
.type k1_qkv_kernel,@function
k1_qkv_kernel:
    s_cmp_ge_u32 s2, 256
    s_cbranch_scc1 L_k1_qkv_kernel_end
    s_load_dwordx2 s[4:5], s[0:1], 0
    s_load_dwordx4 s[36:39], s[0:1], 24
    s_load_dwordx2 s[42:43], s[0:1], 48
    s_load_dwordx2 s[44:45], s[0:1], 64
    s_load_dwordx2 s[46:47], s[0:1], 88
    v_lshrrev_b32 v2, 6, v0
    v_and_b32 v1, 63, v0
    v_readfirstlane_b32 s32, v2
    s_and_b32 s33, s2, 7
    s_lshr_b32 s34, s2, 3
    s_lshr_b32 s54, s33, 1
    s_lshl_b32 s54, s54, 2
    s_and_b32 s55, s34, 3
    s_add_u32 s54, s54, s55
    s_and_b32 s55, s33, 1
    s_lshl_b32 s55, s55, 3
    s_lshr_b32 s56, s34, 2
    s_add_u32 s55, s55, s56
    s_cmp_lt_u32 s32, 4
    s_cbranch_scc1 L_k1_qkv_kernel_comp
    s_sub_u32 s35, s32, 4
    v_lshrrev_b32 v2, 3, v1
    v_and_b32 v3, 7, v1
    v_lshrrev_b32 v4, 4, v1
    v_xor_b32 v5, v3, v4
    v_lshlrev_b32 v5, 4, v5
    s_and_b32 s57, s35, 1
    s_lshl_b32 s56, s54, 5
    v_add_u32 v11, s56, v2
    s_lshr_b32 s58, s35, 1
    s_lshl_b32 s58, s58, 10
    s_cmp_eq_u32 s35, 0
    s_cbranch_scc1 L_k1_qkv_kernel_plus
    s_cmp_eq_u32 s35, 3
    s_cbranch_scc1 L_k1_qkv_kernel_plus
    s_sub_u32 s59, 2048, s58
    v_sub_u32 v12, s59, v11
    v_lshl_add_u32 v16, v12, 10, v5
    v_subrev_u32 v17, 8192, v16
    v_subrev_u32 v18, 16384, v16
    v_subrev_u32 v19, 24576, v16
    s_branch L_k1_qkv_kernel_mird
L_k1_qkv_kernel_plus:
    v_add_u32 v12, s58, v11
    v_lshl_add_u32 v16, v12, 10, v5
    v_add_u32 v17, 8192, v16
    v_add_u32 v18, 16384, v16
    v_add_u32 v19, 24576, v16
L_k1_qkv_kernel_mird:
    s_add_u32 s58, s58, 512
    v_mov_b32 v13, s58
    v_lshl_add_u32 v13, v13, 10, v5
    v_cmp_eq_u32 vcc, 0, v11
    s_cmp_eq_u32 s57, 1
    s_cselect_b64 s[58:59], -1, 0
    s_and_b64 vcc, vcc, s[58:59]
    v_cndmask_b32 v16, v16, v13, vcc
    v_xor_b32 v17, 64, v17
    v_xor_b32 v19, 64, v19
    v_bfe_u32 v6, v1, 4, 1
    v_lshlrev_b32 v6, 2, v6
    v_xor_b32 v6, v6, v3
    v_lshlrev_b32 v6, 4, v6
    v_mul_u32_u24 v7, 3072, v2
    v_add_u32 v6, v6, v7
    s_lshl_b32 s58, s55, 7
    v_add_u32 v20, s58, v6
    v_add_u32 v21, 8*3072, v20
    v_lshrrev_b32 v6, 2, v1
    v_mul_u32_u24 v6, 3072, v6
    v_and_b32 v7, 3, v1
    v_lshl_add_u32 v6, v7, 4, v6
    s_lshl_b32 s58, s55, 6
    s_add_u32 s58, s58, 2048
    v_add_u32 v22, s58, v6
    s_lshl_b32 s56, s55, 4
    s_lshl_b32 s58, s57, 3
    s_add_u32 s56, s56, s58
    v_add_u32 v11, s56, v2
    v_lshl_add_u32 v23, v11, 10, v5
    s_lshl_b32 s58, s57, 6
    v_xor_b32 v23, s58, v23
    s_mul_i32 s71, s35, 16*3072
    s_lshr_b32 s70, s34, 2
    s_and_b32 s72, s34, 3
    s_lshl_b32 s72, s72, 1
    s_add_u32 s70, s70, s72
    s_and_b32 s70, s70, 7
    s_lshl_b32 s56, s70, 7
    s_mul_i32 s57, s70, 196608
    s_add_u32 s57, s57, s71
    s_lshl_b32 s61, s35, 12
    s_lshl_b32 s62, s35, 11
    s_lshl_b32 s63, s35, 10
    s_waitcnt lgkmcnt(0)
    s_mov_b32 s8, s4
    s_mov_b32 s9, s5
    s_mov_b32 s10, 0x200000
    s_mov_b32 s11, 0x20000
    s_mov_b32 s16, s42
    s_mov_b32 s17, s43
    s_mov_b32 s18, 0x180000
    s_mov_b32 s19, 0x20000
    s_cmp_lt_u32 s35, 2
    s_cselect_b32 s20, s36, s38
    s_cselect_b32 s21, s37, s39
    s_mov_b32 s22, 0x80000
    s_mov_b32 s23, 0x20000
    s_mov_b32 s50, 0
    s_mov_b32 s72, 0
    s_mov_b32 s73, s56
    s_mov_b32 s74, 0
    s_mov_b32 s75, 510
    s_mov_b32 s76, 255
    s_mov_b32 s84, 256
    s_mov_b32 s85, 252
L_k1_qkv_kernel_tick:
    s_bitcmp1_b32 s75, s74
    s_cbranch_scc0 L_k1_qkv_kernel_tk1
    s_and_b32 s52, s50, 3
    s_lshl_b32 s52, s52, 13
    s_add_u32 s52, s52, 131072
    s_add_u32 s65, s52, s62
    s_add_u32 m0, s65, 0
    s_nop 0
    buffer_load_dwordx4 v20, s[16:19], s57 offen lds
    s_add_u32 m0, s65, 1024
    s_nop 0
    buffer_load_dwordx4 v21, s[16:19], s57 offen lds
    s_add_u32 s70, s70, 1
    s_and_b32 s70, s70, 7
    s_lshl_b32 s56, s70, 7
    s_mul_i32 s57, s70, 196608
    s_add_u32 s57, s57, s71
    s_add_u32 s50, s50, 1
L_k1_qkv_kernel_tk1:
    s_bitcmp1_b32 s76, s74
    s_cbranch_scc0 L_k1_qkv_kernel_tk2
    s_lshl_b32 s65, s72, 14
    s_add_u32 s65, s65, s61
    s_add_u32 m0, s65, 0
    s_nop 0
    buffer_load_dwordx4 v16, s[8:11], s73 offen lds
    s_add_u32 m0, s65, 1024
    s_nop 0
    buffer_load_dwordx4 v17, s[8:11], s73 offen lds
    s_add_u32 m0, s65, 2048
    s_nop 0
    buffer_load_dwordx4 v18, s[8:11], s73 offen lds
    s_add_u32 m0, s65, 3072
    s_nop 0
    buffer_load_dwordx4 v19, s[8:11], s73 offen lds
    s_add_u32 s73, s73, 128
    s_and_b32 s73, s73, 1023
    s_add_u32 s72, s72, 1
L_k1_qkv_kernel_tk2:
    s_bitcmp1_b32 s84, s74
    s_cbranch_scc0 L_k1_qkv_kernel_tw0
    s_waitcnt vmcnt(6)
    s_barrier
L_k1_qkv_kernel_tw0:
    s_bitcmp1_b32 s85, s74
    s_cbranch_scc0 L_k1_qkv_kernel_tw1
    s_waitcnt vmcnt(10)
    s_barrier
L_k1_qkv_kernel_tw1:
    s_add_u32 s74, s74, 1
    s_cmp_lt_u32 s74, 9
    s_cbranch_scc1 L_k1_qkv_kernel_tick
L_k1_qkv_kernel_issue2:
    s_and_b32 s52, s50, 3
    s_lshl_b32 s52, s52, 13
    s_add_u32 s52, s52, 131072
    s_add_u32 s65, s52, s63
    s_mov_b32 m0, s65
    s_nop 0
    buffer_load_dwordx4 v22, s[16:19], s57 offen lds
    s_add_u32 m0, s65, 4096
    s_nop 0
    buffer_load_dwordx4 v23, s[20:23], s56 offen lds
    s_add_u32 s70, s70, 1
    s_and_b32 s70, s70, 7
    s_lshl_b32 s56, s70, 7
    s_mul_i32 s57, s70, 196608
    s_add_u32 s57, s57, s71
    s_add_u32 s50, s50, 1
    s_cmp_eq_u32 s50, 16
    s_cbranch_scc1 L_k1_qkv_kernel_ld16
    s_waitcnt vmcnt(2)
    s_barrier
    s_branch L_k1_qkv_kernel_issue2
L_k1_qkv_kernel_ld16:
    s_mov_b32 s28, s44
    s_mov_b32 s29, s45
    s_mov_b32 s30, 0x400
    s_mov_b32 s31, 0x20000
    s_lshl_b32 s48, s2, 3
    s_lshl_b32 s49, s35, 1
    s_add_u32 s48, s48, s49
    s_lshl_b32 s49, s48, 10
    v_lshlrev_b32 v12, 4, v1
    buffer_load_dwordx4 v[24:27], v12, s[8:11], s49 offen
    buffer_load_dwordx4 v[28:31], v12, s[8:11], s49 offen offset:1024
    buffer_load_dwordx4 v[32:35], v12, s[28:31], 0 offen
    s_waitcnt vmcnt(5)
    s_barrier
    s_waitcnt vmcnt(3)
    s_barrier
    s_barrier
    s_mov_b32 s24, s46
    s_mov_b32 s25, s47
    s_mov_b32 s26, 0xd00000
    s_mov_b32 s27, 0x20000
    v_mov_b32 v16, 0
    v_mov_b32 v17, 0
    s_waitcnt vmcnt(0)
    v_dot2_f32_bf16 v16, v24, v32, v16
    v_dot2_f32_bf16 v17, v28, v32, v17
    v_dot2_f32_bf16 v16, v25, v33, v16
    v_dot2_f32_bf16 v17, v29, v33, v17
    v_dot2_f32_bf16 v16, v26, v34, v16
    v_dot2_f32_bf16 v17, v30, v34, v17
    v_dot2_f32_bf16 v16, v27, v35, v16
    v_dot2_f32_bf16 v17, v31, v35, v17
    s_nop 2
    s_nop 0
    v_add_f32_dpp v16, v16, v16 row_shr:1 row_mask:0xf bank_mask:0xf
    v_add_f32_dpp v17, v17, v17 row_shr:1 row_mask:0xf bank_mask:0xf
    s_nop 0
    v_add_f32_dpp v16, v16, v16 row_shr:2 row_mask:0xf bank_mask:0xf
    v_add_f32_dpp v17, v17, v17 row_shr:2 row_mask:0xf bank_mask:0xf
    s_nop 0
    v_add_f32_dpp v16, v16, v16 row_shr:4 row_mask:0xf bank_mask:0xf
    v_add_f32_dpp v17, v17, v17 row_shr:4 row_mask:0xf bank_mask:0xf
    s_nop 0
    v_add_f32_dpp v16, v16, v16 row_shr:8 row_mask:0xf bank_mask:0xf
    v_add_f32_dpp v17, v17, v17 row_shr:8 row_mask:0xf bank_mask:0xf
    s_nop 0
    v_add_f32_dpp v16, v16, v16 row_bcast:15 row_mask:0xa bank_mask:0xf
    v_add_f32_dpp v17, v17, v17 row_bcast:15 row_mask:0xa bank_mask:0xf
    s_nop 0
    v_add_f32_dpp v16, v16, v16 row_bcast:31 row_mask:0xc bank_mask:0xf
    v_add_f32_dpp v17, v17, v17 row_bcast:31 row_mask:0xc bank_mask:0xf
    v_mul_f32 v16, 0xbfb8aa3b, v16
    v_mul_f32 v17, 0xbfb8aa3b, v17
    v_exp_f32 v16, v16
    v_exp_f32 v17, v17
    s_nop 0
    v_add_f32 v16, 1.0, v16
    v_add_f32 v17, 1.0, v17
    v_rcp_f32 v16, v16
    v_rcp_f32 v17, v17
    s_lshl_b32 s49, s48, 2
    s_add_u32 s49, s49, 12582912
    v_mov_b32 v18, 0
    s_mov_b32 exec_lo, 0
    s_mov_b32 exec_hi, 0x80000000
    buffer_store_dwordx2 v[16:17], v18, s[24:27], s49 offen
    s_mov_b64 exec, -1
    s_cmp_lt_u32 s2, 16
    s_cbranch_scc0 L_k1_qkv_kernel_nopf
    s_cmp_eq_u32 s32, 7
    s_cbranch_scc0 L_k1_qkv_kernel_nopf
    s_getpc_b64 s[72:73]
L_k1_qkv_kernel_pc:
    s_add_u32 s72, s72, k2_attn_kernel-L_k1_qkv_kernel_pc
    s_addc_u32 s73, s73, 0
    v_lshlrev_b32 v18, 4, v1
    global_load_dwordx4 v[36:39], v18, s[72:73]
    v_add_u32 v18, 1024, v18
    global_load_dwordx4 v[40:43], v18, s[72:73]
    v_add_u32 v18, 1024, v18
    global_load_dwordx4 v[44:47], v18, s[72:73]
    v_add_u32 v18, 1024, v18
    global_load_dwordx4 v[48:51], v18, s[72:73]
    v_add_u32 v18, 1024, v18
    global_load_dwordx4 v[52:55], v18, s[72:73]
    v_add_u32 v18, 1024, v18
    global_load_dwordx4 v[56:59], v18, s[72:73]
    v_add_u32 v18, 1024, v18
    v_lshlrev_b32 v18, 4, v1
    v_add_u32 v18, L_k2_attn_kernel_end-k2_attn_kernel-1024, v18
    global_load_dwordx4 v[60:63], v18, s[72:73]
L_k1_qkv_kernel_nopf:
    s_cmp_eq_u32 s2, 0
    s_cbranch_scc0 L_k1_qkv_kernel_fin
    s_cmp_eq_u32 s32, 4
    s_cbranch_scc0 L_k1_qkv_kernel_fin
    v_mov_b32 v20, 0
    v_mov_b32 v21, 0
    v_mov_b32 v22, 0
    v_mov_b32 v23, 0
    v_lshlrev_b32 v18, 4, v1
    s_mov_b32 s49, 13107200
    buffer_store_dwordx4 v[20:23], v18, s[24:27], s49 offen sc1
    s_branch L_k1_qkv_kernel_fin
L_k1_qkv_kernel_comp:
    s_cmp_lt_u32 s2, 16
    s_cbranch_scc0 L_k1_qkv_kernel_nspf
    s_cmp_eq_u32 s32, 3
    s_cbranch_scc0 L_k1_qkv_kernel_nspf
    s_getpc_b64 s[72:73]
L_k1_qkv_kernel_pc0:
    s_sub_u32 s72, s72, L_k1_qkv_kernel_pc0-k1_qkv_kernel
    s_subb_u32 s73, s73, 0
    v_lshlrev_b32 v18, 4, v1
    global_load_dwordx4 v[144:147], v18, s[72:73]
    v_add_u32 v18, 1024, v18
    global_load_dwordx4 v[148:151], v18, s[72:73]
    v_add_u32 v18, 1024, v18
    global_load_dwordx4 v[152:155], v18, s[72:73]
    v_add_u32 v18, 1024, v18
    global_load_dwordx4 v[156:159], v18, s[72:73]
    v_add_u32 v18, 1024, v18
    global_load_dwordx4 v[160:163], v18, s[72:73]
    v_add_u32 v18, 1024, v18
    global_load_dwordx4 v[164:167], v18, s[72:73]
    v_add_u32 v18, 1024, v18
    global_load_dwordx4 v[168:171], v18, s[72:73]
    v_add_u32 v18, 1024, v18
L_k1_qkv_kernel_nspf:
    s_lshr_b32 s35, s32, 1
    s_and_b32 s40, s32, 1
    v_and_b32 v8, 31, v1
    v_lshrrev_b32 v9, 5, v1
    v_and_b32 v10, 0x13, v8
    v_and_b32 v11, 4, v8
    v_lshl_or_b32 v10, v11, 1, v10
    v_and_b32 v11, 8, v8
    v_lshrrev_b32 v11, 1, v11
    v_or_b32 v10, v10, v11
    s_lshl_b32 s63, s35, 6
    v_add_u32 v11, s63, v10
    v_lshrrev_b32 v15, 1, v11
    v_and_b32 v15, 7, v15
    v_xor_b32 v15, v15, v9
    v_lshlrev_b32 v15, 4, v15
    v_lshl_add_u32 v16, v11, 7, v15
    v_xor_b32 v17, 32, v16
    v_xor_b32 v18, 64, v16
    v_xor_b32 v19, 96, v16
    v_bfe_u32 v11, v1, 2, 2
    v_lshl_add_u32 v11, v9, 3, v11
    v_bfe_u32 v12, v1, 4, 1
    v_and_b32 v13, 3, v1
    v_lshlrev_b32 v20, 7, v11
    v_bfe_u32 v14, v1, 3, 1
    v_xor_b32 v14, s40, v14
    v_lshl_add_u32 v20, v14, 6, v20
    v_lshl_add_u32 v20, v12, 5, v20
    v_lshrrev_b32 v14, 1, v13
    v_lshl_add_u32 v20, v14, 4, v20
    v_and_b32 v14, 1, v13
    v_lshl_add_u32 v20, v14, 3, v20
    v_lshlrev_b32 v22, 6, v11
    v_lshl_add_u32 v22, v12, 5, v22
    v_lshl_add_u32 v22, v13, 3, v22
    v_lshrrev_b32 v15, 1, v8
    v_and_b32 v15, 7, v15
    v_xor_b32 v15, v15, v9
    v_lshlrev_b32 v15, 4, v15
    v_lshl_add_u32 v24, v8, 7, v15
    v_add_u32 v24, 4096, v24
    v_xor_b32 v25, 32, v24
    v_xor_b32 v26, 64, v24
    v_xor_b32 v27, 96, v24
    s_cmp_eq_u32 s55, 0
    s_cselect_b32 s66, 0x10000, 0
    s_mov_b32 s67, s66
    v_mov_b32 v14, 0xbf803f80
    s_mov_b32 s50, 0
    v_mov_b32 v32, 0
    v_mov_b32 v33, 0
    v_mov_b32 v34, 0
    v_mov_b32 v35, 0
    v_mov_b32 v36, 0
    v_mov_b32 v37, 0
    v_mov_b32 v38, 0
    v_mov_b32 v39, 0
    v_mov_b32 v40, 0
    v_mov_b32 v41, 0
    v_mov_b32 v42, 0
    v_mov_b32 v43, 0
    v_mov_b32 v44, 0
    v_mov_b32 v45, 0
    v_mov_b32 v46, 0
    v_mov_b32 v47, 0
    v_mov_b32 v48, 0
    v_mov_b32 v49, 0
    v_mov_b32 v50, 0
    v_mov_b32 v51, 0
    v_mov_b32 v52, 0
    v_mov_b32 v53, 0
    v_mov_b32 v54, 0
    v_mov_b32 v55, 0
    v_mov_b32 v56, 0
    v_mov_b32 v57, 0
    v_mov_b32 v58, 0
    v_mov_b32 v59, 0
    v_mov_b32 v60, 0
    v_mov_b32 v61, 0
    v_mov_b32 v62, 0
    v_mov_b32 v63, 0
    s_waitcnt vmcnt(0) lgkmcnt(0)
    s_barrier
    s_mov_b32 s51, 0
    s_and_b32 s52, s51, 7
    s_lshl_b32 s52, s52, 14
    s_and_b32 s53, s51, 3
    s_lshl_b32 s53, s53, 13
    s_add_u32 s53, s53, 131072
    v_add_u32 v28, s52, v16
    v_add_u32 v29, s52, v17
    v_add_u32 v30, s52, v18
    v_add_u32 v31, s52, v19
    v_add_u32 v21, s53, v20
    ds_read_b128 v[96:99], v28
    ds_read_b128 v[100:103], v28 offset:4096
    ds_read_b64_tr_b16 v[104:105], v21 offset:0
    ds_read_b64_tr_b16 v[106:107], v21 offset:512
    ds_read_b128 v[108:111], v29
    ds_read_b128 v[112:115], v29 offset:4096
    ds_read_b64_tr_b16 v[116:117], v21 offset:2048
    ds_read_b64_tr_b16 v[118:119], v21 offset:2560
    ds_read_b128 v[120:123], v30
    ds_read_b128 v[124:127], v30 offset:4096
    ds_read_b64_tr_b16 v[128:129], v21 offset:4096
    ds_read_b64_tr_b16 v[130:131], v21 offset:4608
L_k1_qkv_kernel_p1:
    s_waitcnt lgkmcnt(8)
    v_mfma_f32_32x32x16_bf16 v[32:47], v[104:107], v[96:99], v[32:47]
    ds_read_b128 v[132:135], v31
    ds_read_b128 v[136:139], v31 offset:4096
    v_mfma_f32_32x32x16_bf16 v[48:63], v[104:107], v[100:103], v[48:63]
    ds_read_b64_tr_b16 v[140:141], v21 offset:6144
    ds_read_b64_tr_b16 v[142:143], v21 offset:6656
    s_add_u32 s51, s50, 1
    s_and_b32 s52, s51, 7
    s_lshl_b32 s52, s52, 14
    s_and_b32 s53, s51, 3
    s_lshl_b32 s53, s53, 13
    s_add_u32 s53, s53, 131072
    v_add_u32 v28, s52, v16
    v_add_u32 v29, s52, v17
    v_add_u32 v30, s52, v18
    v_add_u32 v31, s52, v19
    v_add_u32 v21, s53, v20
    s_barrier
    s_waitcnt lgkmcnt(8)
    v_mfma_f32_32x32x16_bf16 v[32:47], v[116:119], v[108:111], v[32:47]
    ds_read_b128 v[96:99], v28
    ds_read_b128 v[100:103], v28 offset:4096
    v_mfma_f32_32x32x16_bf16 v[48:63], v[116:119], v[112:115], v[48:63]
    ds_read_b64_tr_b16 v[104:105], v21 offset:0
    ds_read_b64_tr_b16 v[106:107], v21 offset:512
    s_waitcnt lgkmcnt(8)
    v_mfma_f32_32x32x16_bf16 v[32:47], v[128:131], v[120:123], v[32:47]
    ds_read_b128 v[108:111], v29
    ds_read_b128 v[112:115], v29 offset:4096
    v_mfma_f32_32x32x16_bf16 v[48:63], v[128:131], v[124:127], v[48:63]
    ds_read_b64_tr_b16 v[116:117], v21 offset:2048
    ds_read_b64_tr_b16 v[118:119], v21 offset:2560
    s_waitcnt lgkmcnt(8)
    v_mfma_f32_32x32x16_bf16 v[32:47], v[140:143], v[132:135], v[32:47]
    ds_read_b128 v[120:123], v30
    ds_read_b128 v[124:127], v30 offset:4096
    v_mfma_f32_32x32x16_bf16 v[48:63], v[140:143], v[136:139], v[48:63]
    ds_read_b64_tr_b16 v[128:129], v21 offset:4096
    ds_read_b64_tr_b16 v[130:131], v21 offset:4608
    s_add_u32 s50, s50, 1
    s_cmp_lt_u32 s50, 7
    s_cbranch_scc1 L_k1_qkv_kernel_p1
    s_mov_b32 s24, s46
    s_mov_b32 s25, s47
    s_mov_b32 s26, 0xd00000
    s_mov_b32 s27, 0x20000
    s_lshl_b32 s57, s35, 5
    s_add_u32 s56, s54, s57
    s_cmp_ge_u32 s55, 8
    s_cselect_b32 s57, 17, 16
    s_cselect_b32 s58, 11, 10
    s_cselect_b32 s59, 2097152, 0
    s_cselect_b32 s60, 1.0, 0x3eb8aa3b
    s_lshl_b32 s57, 1, s57
    s_lshl_b32 s61, s56, s58
    s_add_u32 s59, s59, s61
    s_lshl_b32 s63, 16, s58
    s_and_b32 s62, s55, 7
    s_lshl_b32 s62, s62, 2
    s_lshl_b32 s64, s40, 1
    s_add_u32 s62, s62, s64
    s_mul_i32 s62, s62, s57
    s_add_u32 s59, s59, s62
    s_add_u32 s68, s59, s57
    s_add_u32 s69, s59, s63
    s_add_u32 s70, s68, s63
    v_lshlrev_b32 v11, 9, v9
    v_lshl_add_u32 v11, v10, 4, v11
    s_cmp_eq_u32 s40, 0
    s_cbranch_scc0 L_k1_qkv_kernel_roleF
    s_waitcnt lgkmcnt(8)
    v_mfma_f32_32x32x16_bf16 v[32:47], v[104:107], v[96:99], v[32:47]
    ds_read_b128 v[132:135], v31
    ds_read_b128 v[136:139], v31 offset:4096
    v_mfma_f32_32x32x16_bf16 v[48:63], v[104:107], v[100:103], v[48:63]
    ds_read_b64_tr_b16 v[140:141], v21 offset:6144
    ds_read_b64_tr_b16 v[142:143], v21 offset:6656
    s_add_u32 s51, s50, 1
    s_and_b32 s52, s51, 7
    s_lshl_b32 s52, s52, 14
    s_and_b32 s53, s51, 3
    s_lshl_b32 s53, s53, 13
    s_add_u32 s53, s53, 131072
    v_add_u32 v28, s52, v16
    v_add_u32 v29, s52, v17
    v_add_u32 v30, s52, v18
    v_add_u32 v31, s52, v19
    v_add_u32 v21, s53, v22
    s_barrier
    s_waitcnt lgkmcnt(8)
    v_mfma_f32_32x32x16_bf16 v[32:47], v[116:119], v[108:111], v[32:47]
    ds_read_b128 v[96:99], v28
    ds_read_b128 v[100:103], v28 offset:4096
    v_mfma_f32_32x32x16_bf16 v[48:63], v[116:119], v[112:115], v[48:63]
    ds_read_b64_tr_b16 v[104:105], v21 offset:0
    ds_read_b64_tr_b16 v[106:107], v21 offset:256
    s_waitcnt lgkmcnt(8)
    v_mfma_f32_32x32x16_bf16 v[32:47], v[128:131], v[120:123], v[32:47]
    ds_read_b128 v[108:111], v29
    ds_read_b128 v[112:115], v29 offset:4096
    v_mfma_f32_32x32x16_bf16 v[48:63], v[128:131], v[124:127], v[48:63]
    ds_read_b64_tr_b16 v[116:117], v21 offset:1024
    ds_read_b64_tr_b16 v[118:119], v21 offset:1280
    s_waitcnt lgkmcnt(8)
    v_mfma_f32_32x32x16_bf16 v[32:47], v[140:143], v[132:135], v[32:47]
    ds_read_b128 v[120:123], v30
    ds_read_b128 v[124:127], v30 offset:4096
    v_mfma_f32_32x32x16_bf16 v[48:63], v[140:143], v[136:139], v[48:63]
    ds_read_b64_tr_b16 v[128:129], v21 offset:2048
    ds_read_b64_tr_b16 v[130:131], v21 offset:2304
    s_add_u32 s50, s50, 1
    s_waitcnt lgkmcnt(8)
    v_mfma_f32_32x32x16_bf16 v[64:79], v[96:99], v[104:107], 0
    ds_read_b128 v[132:135], v31
    ds_read_b128 v[136:139], v31 offset:4096
    s_nop 7
    s_nop 3
    v_mul_f32 v32, s60, v32
    v_mul_f32 v33, s60, v33
    v_mfma_f32_32x32x16_bf16 v[80:95], v[100:103], v[104:107], 0
    ds_read_b64_tr_b16 v[140:141], v21 offset:3072
    ds_read_b64_tr_b16 v[142:143], v21 offset:3328
    v_mul_f32 v34, s60, v34
    v_mul_f32 v35, s60, v35
    v_mul_f32 v36, s60, v36
    v_mul_f32 v37, s60, v37
    s_add_u32 s51, s50, 1
    s_and_b32 s52, s51, 7
    s_lshl_b32 s52, s52, 14
    s_and_b32 s53, s51, 3
    s_lshl_b32 s53, s53, 13
    s_add_u32 s53, s53, 131072
    v_add_u32 v28, s52, v16
    v_add_u32 v29, s52, v17
    v_add_u32 v30, s52, v18
    v_add_u32 v31, s52, v19
    v_add_u32 v21, s53, v22
    s_barrier
    s_waitcnt lgkmcnt(8)
    v_mfma_f32_32x32x16_bf16 v[64:79], v[108:111], v[116:119], v[64:79]
    ds_read_b128 v[96:99], v28
    ds_read_b128 v[100:103], v28 offset:4096
    v_mul_f32 v38, s60, v38
    v_mul_f32 v39, s60, v39
    v_cvt_pk_bf16_f32 v144, v32, v33
    v_cvt_pk_bf16_f32 v145, v34, v35
    v_mfma_f32_32x32x16_bf16 v[80:95], v[112:115], v[116:119], v[80:95]
    ds_read_b64_tr_b16 v[104:105], v21 offset:0
    ds_read_b64_tr_b16 v[106:107], v21 offset:256
    v_cvt_pk_bf16_f32 v146, v36, v37
    v_cvt_pk_bf16_f32 v147, v38, v39
    buffer_store_dwordx4 v[144:147], v11, s[24:27], s59 offen sc1
    v_mul_f32 v40, s60, v40
    s_waitcnt lgkmcnt(8)
    v_mfma_f32_32x32x16_bf16 v[64:79], v[120:123], v[128:131], v[64:79]
    ds_read_b128 v[108:111], v29
    ds_read_b128 v[112:115], v29 offset:4096
    v_mul_f32 v41, s60, v41
    v_mul_f32 v42, s60, v42
    v_mul_f32 v43, s60, v43
    v_mul_f32 v44, s60, v44
    v_mfma_f32_32x32x16_bf16 v[80:95], v[124:127], v[128:131], v[80:95]
    ds_read_b64_tr_b16 v[116:117], v21 offset:1024
    ds_read_b64_tr_b16 v[118:119], v21 offset:1280
    v_mul_f32 v45, s60, v45
    v_mul_f32 v46, s60, v46
    v_mul_f32 v47, s60, v47
    v_cvt_pk_bf16_f32 v148, v40, v41
    s_waitcnt lgkmcnt(8)
    v_mfma_f32_32x32x16_bf16 v[64:79], v[132:135], v[140:143], v[64:79]
    ds_read_b128 v[120:123], v30
    ds_read_b128 v[124:127], v30 offset:4096
    v_cvt_pk_bf16_f32 v149, v42, v43
    v_cvt_pk_bf16_f32 v150, v44, v45
    v_cvt_pk_bf16_f32 v151, v46, v47
    buffer_store_dwordx4 v[148:151], v11, s[24:27], s68 offen sc1
    v_mfma_f32_32x32x16_bf16 v[80:95], v[136:139], v[140:143], v[80:95]
    ds_read_b64_tr_b16 v[128:129], v21 offset:2048
    ds_read_b64_tr_b16 v[130:131], v21 offset:2304
    s_add_u32 s50, s50, 1
    s_waitcnt lgkmcnt(8)
    v_mfma_f32_32x32x16_bf16 v[64:79], v[96:99], v[104:107], v[64:79]
    ds_read_b128 v[132:135], v31
    ds_read_b128 v[136:139], v31 offset:4096
    v_mul_f32 v48, s60, v48
    v_mul_f32 v49, s60, v49
    v_mul_f32 v50, s60, v50
    v_mul_f32 v51, s60, v51
    v_mfma_f32_32x32x16_bf16 v[80:95], v[100:103], v[104:107], v[80:95]
    ds_read_b64_tr_b16 v[140:141], v21 offset:3072
    ds_read_b64_tr_b16 v[142:143], v21 offset:3328
    v_mul_f32 v52, s60, v52
    v_mul_f32 v53, s60, v53
    v_mul_f32 v54, s60, v54
    v_mul_f32 v55, s60, v55
    s_add_u32 s51, s50, 1
    s_and_b32 s52, s51, 7
    s_lshl_b32 s52, s52, 14
    s_and_b32 s53, s51, 3
    s_lshl_b32 s53, s53, 13
    s_add_u32 s53, s53, 131072
    v_add_u32 v28, s52, v16
    v_add_u32 v29, s52, v17
    v_add_u32 v30, s52, v18
    v_add_u32 v31, s52, v19
    v_add_u32 v21, s53, v22
    s_barrier
    s_waitcnt lgkmcnt(8)
    v_mfma_f32_32x32x16_bf16 v[64:79], v[108:111], v[116:119], v[64:79]
    ds_read_b128 v[96:99], v28
    ds_read_b128 v[100:103], v28 offset:4096
    v_cvt_pk_bf16_f32 v152, v48, v49
    v_cvt_pk_bf16_f32 v153, v50, v51
    v_cvt_pk_bf16_f32 v154, v52, v53
    v_cvt_pk_bf16_f32 v155, v54, v55
    v_mfma_f32_32x32x16_bf16 v[80:95], v[112:115], v[116:119], v[80:95]
    ds_read_b64_tr_b16 v[104:105], v21 offset:0
    ds_read_b64_tr_b16 v[106:107], v21 offset:256
    buffer_store_dwordx4 v[152:155], v11, s[24:27], s69 offen sc1
    v_mul_f32 v56, s60, v56
    v_mul_f32 v57, s60, v57
    v_mul_f32 v58, s60, v58
    s_waitcnt lgkmcnt(8)
    v_mfma_f32_32x32x16_bf16 v[64:79], v[120:123], v[128:131], v[64:79]
    ds_read_b128 v[108:111], v29
    ds_read_b128 v[112:115], v29 offset:4096
    v_mul_f32 v59, s60, v59
    v_mul_f32 v60, s60, v60
    v_mul_f32 v61, s60, v61
    v_mul_f32 v62, s60, v62
    v_mfma_f32_32x32x16_bf16 v[80:95], v[124:127], v[128:131], v[80:95]
    ds_read_b64_tr_b16 v[116:117], v21 offset:1024
    ds_read_b64_tr_b16 v[118:119], v21 offset:1280
    v_mul_f32 v63, s60, v63
    v_cvt_pk_bf16_f32 v156, v56, v57
    v_cvt_pk_bf16_f32 v157, v58, v59
    v_cvt_pk_bf16_f32 v158, v60, v61
    s_waitcnt lgkmcnt(8)
    v_mfma_f32_32x32x16_bf16 v[64:79], v[132:135], v[140:143], v[64:79]
    ds_read_b128 v[120:123], v30
    ds_read_b128 v[124:127], v30 offset:4096
    v_cvt_pk_bf16_f32 v159, v62, v63
    buffer_store_dwordx4 v[156:159], v11, s[24:27], s70 offen sc1
    v_mfma_f32_32x32x16_bf16 v[80:95], v[136:139], v[140:143], v[80:95]
    ds_read_b64_tr_b16 v[128:129], v21 offset:2048
    ds_read_b64_tr_b16 v[130:131], v21 offset:2304
    s_add_u32 s50, s50, 1
L_k1_qkv_kernel_p2V:
    s_waitcnt lgkmcnt(8)
    v_mfma_f32_32x32x16_bf16 v[64:79], v[96:99], v[104:107], v[64:79]
    ds_read_b128 v[132:135], v31
    ds_read_b128 v[136:139], v31 offset:4096
    v_mfma_f32_32x32x16_bf16 v[80:95], v[100:103], v[104:107], v[80:95]
    ds_read_b64_tr_b16 v[140:141], v21 offset:3072
    ds_read_b64_tr_b16 v[142:143], v21 offset:3328
    s_add_u32 s51, s50, 1
    s_and_b32 s52, s51, 7
    s_lshl_b32 s52, s52, 14
    s_and_b32 s53, s51, 3
    s_lshl_b32 s53, s53, 13
    s_add_u32 s53, s53, 131072
    v_add_u32 v28, s52, v16
    v_add_u32 v29, s52, v17
    v_add_u32 v30, s52, v18
    v_add_u32 v31, s52, v19
    v_add_u32 v21, s53, v22
    s_barrier
    s_waitcnt lgkmcnt(8)
    v_mfma_f32_32x32x16_bf16 v[64:79], v[108:111], v[116:119], v[64:79]
    ds_read_b128 v[96:99], v28
    ds_read_b128 v[100:103], v28 offset:4096
    v_mfma_f32_32x32x16_bf16 v[80:95], v[112:115], v[116:119], v[80:95]
    ds_read_b64_tr_b16 v[104:105], v21 offset:0
    ds_read_b64_tr_b16 v[106:107], v21 offset:256
    s_waitcnt lgkmcnt(8)
    v_mfma_f32_32x32x16_bf16 v[64:79], v[120:123], v[128:131], v[64:79]
    ds_read_b128 v[108:111], v29
    ds_read_b128 v[112:115], v29 offset:4096
    v_mfma_f32_32x32x16_bf16 v[80:95], v[124:127], v[128:131], v[80:95]
    ds_read_b64_tr_b16 v[116:117], v21 offset:1024
    ds_read_b64_tr_b16 v[118:119], v21 offset:1280
    s_waitcnt lgkmcnt(8)
    v_mfma_f32_32x32x16_bf16 v[64:79], v[132:135], v[140:143], v[64:79]
    ds_read_b128 v[120:123], v30
    ds_read_b128 v[124:127], v30 offset:4096
    v_mfma_f32_32x32x16_bf16 v[80:95], v[136:139], v[140:143], v[80:95]
    ds_read_b64_tr_b16 v[128:129], v21 offset:2048
    ds_read_b64_tr_b16 v[130:131], v21 offset:2304
    s_add_u32 s50, s50, 1
    s_cmp_lt_u32 s50, 15
    s_cbranch_scc1 L_k1_qkv_kernel_p2V
    s_waitcnt lgkmcnt(8)
    v_mfma_f32_32x32x16_bf16 v[64:79], v[96:99], v[104:107], v[64:79]
    ds_read_b128 v[132:135], v31
    ds_read_b128 v[136:139], v31 offset:4096
    v_mfma_f32_32x32x16_bf16 v[80:95], v[100:103], v[104:107], v[80:95]
    ds_read_b64_tr_b16 v[140:141], v21 offset:3072
    ds_read_b64_tr_b16 v[142:143], v21 offset:3328
    s_waitcnt lgkmcnt(8)
    v_mfma_f32_32x32x16_bf16 v[64:79], v[108:111], v[116:119], v[64:79]
    v_mfma_f32_32x32x16_bf16 v[80:95], v[112:115], v[116:119], v[80:95]
    s_waitcnt lgkmcnt(4)
    v_mfma_f32_32x32x16_bf16 v[64:79], v[120:123], v[128:131], v[64:79]
    v_mfma_f32_32x32x16_bf16 v[80:95], v[124:127], v[128:131], v[80:95]
    s_waitcnt lgkmcnt(0)
    v_mfma_f32_32x32x16_bf16 v[64:79], v[132:135], v[140:143], v[64:79]
    v_mfma_f32_32x32x16_bf16 v[80:95], v[136:139], v[140:143], v[80:95]
    s_add_u32 s50, s50, 1
    s_nop 15
    s_barrier
    s_lshl_b32 s57, s35, 5
    s_add_u32 s58, s54, s57
    v_lshrrev_b32 v19, 4, v8
    v_lshlrev_b32 v19, 17, v19
    v_lshl_add_u32 v19, v9, 9, v19
    v_and_b32 v13, 15, v8
    v_lshl_add_u32 v19, v13, 4, v19
    s_lshl_b32 s61, s55, 18
    s_lshl_b32 s62, s58, 11
    s_add_u32 s61, s61, s62
    s_add_u32 s61, s61, 2098176
    v_cvt_pk_bf16_f32 v96, v64, v65
    v_cvt_pk_bf16_f32 v97, v66, v67
    v_cvt_pk_bf16_f32 v98, v68, v69
    v_cvt_pk_bf16_f32 v99, v70, v71
    buffer_store_dwordx4 v[96:99], v19, s[24:27], s61 offen offset:0 sc1
    v_cvt_pk_bf16_f32 v100, v72, v73
    v_cvt_pk_bf16_f32 v101, v74, v75
    v_cvt_pk_bf16_f32 v102, v76, v77
    v_cvt_pk_bf16_f32 v103, v78, v79
    buffer_store_dwordx4 v[100:103], v19, s[24:27], s61 offen offset:256 sc1
    s_add_u32 s61, s61, 32768
    v_cvt_pk_bf16_f32 v104, v80, v81
    v_cvt_pk_bf16_f32 v105, v82, v83
    v_cvt_pk_bf16_f32 v106, v84, v85
    v_cvt_pk_bf16_f32 v107, v86, v87
    buffer_store_dwordx4 v[104:107], v19, s[24:27], s61 offen offset:0 sc1
    v_cvt_pk_bf16_f32 v108, v88, v89
    v_cvt_pk_bf16_f32 v109, v90, v91
    v_cvt_pk_bf16_f32 v110, v92, v93
    v_cvt_pk_bf16_f32 v111, v94, v95
    buffer_store_dwordx4 v[108:111], v19, s[24:27], s61 offen offset:256 sc1
    s_branch L_k1_qkv_kernel_fin
L_k1_qkv_kernel_roleF:
    s_waitcnt lgkmcnt(8)
    v_mfma_f32_32x32x16_bf16 v[32:47], v[104:107], v[96:99], v[32:47]
    ds_read_b128 v[132:135], v31
    ds_read_b128 v[136:139], v31 offset:4096
    v_mfma_f32_32x32x16_bf16 v[48:63], v[104:107], v[100:103], v[48:63]
    ds_read_b64_tr_b16 v[140:141], v21 offset:6144
    ds_read_b64_tr_b16 v[142:143], v21 offset:6656
    s_add_u32 s51, s50, 1
    s_and_b32 s52, s51, 7
    s_lshl_b32 s52, s52, 14
    s_and_b32 s53, s51, 3
    s_lshl_b32 s53, s53, 13
    s_add_u32 s53, s53, 131072
    v_add_u32 v28, s52, v16
    v_add_u32 v29, s52, v17
    v_add_u32 v30, s52, v18
    v_add_u32 v31, s52, v19
    v_add_u32 v4, s53, v24
    v_add_u32 v5, s53, v25
    v_add_u32 v6, s53, v26
    v_add_u32 v7, s53, v27
    s_barrier
    s_waitcnt lgkmcnt(8)
    v_mfma_f32_32x32x16_bf16 v[32:47], v[116:119], v[108:111], v[32:47]
    ds_read_b128 v[96:99], v28
    ds_read_b128 v[100:103], v28 offset:4096
    v_mfma_f32_32x32x16_bf16 v[48:63], v[116:119], v[112:115], v[48:63]
    ds_read_b128 v[104:107], v4
    s_waitcnt lgkmcnt(7)
    v_mfma_f32_32x32x16_bf16 v[32:47], v[128:131], v[120:123], v[32:47]
    ds_read_b128 v[108:111], v29
    ds_read_b128 v[112:115], v29 offset:4096
    v_mfma_f32_32x32x16_bf16 v[48:63], v[128:131], v[124:127], v[48:63]
    ds_read_b128 v[116:119], v5
    s_waitcnt lgkmcnt(6)
    v_mfma_f32_32x32x16_bf16 v[32:47], v[140:143], v[132:135], v[32:47]
    ds_read_b128 v[120:123], v30
    ds_read_b128 v[124:127], v30 offset:4096
    v_mfma_f32_32x32x16_bf16 v[48:63], v[140:143], v[136:139], v[48:63]
    ds_read_b128 v[128:131], v6
    s_add_u32 s50, s50, 1
    s_waitcnt lgkmcnt(6)
    v_cndmask_b32 v104, v104, v14, s[66:67]
    v_cndmask_b32 v105, v105, v14, s[66:67]
    v_cndmask_b32 v106, v106, v14, s[66:67]
    v_cndmask_b32 v107, v107, v14, s[66:67]
    s_nop 1
    v_mfma_f32_32x32x16_bf16 v[64:79], v[96:99], v[104:107], 0
    ds_read_b128 v[132:135], v31
    ds_read_b128 v[136:139], v31 offset:4096
    s_nop 7
    s_nop 3
    v_mul_f32 v32, s60, v32
    v_mul_f32 v33, s60, v33
    v_mfma_f32_32x32x16_bf16 v[80:95], v[100:103], v[104:107], 0
    ds_read_b128 v[140:143], v7
    v_mul_f32 v34, s60, v34
    v_mul_f32 v35, s60, v35
    v_mul_f32 v36, s60, v36
    v_mul_f32 v37, s60, v37
    s_add_u32 s51, s50, 1
    s_and_b32 s52, s51, 7
    s_lshl_b32 s52, s52, 14
    s_and_b32 s53, s51, 3
    s_lshl_b32 s53, s53, 13
    s_add_u32 s53, s53, 131072
    v_add_u32 v28, s52, v16
    v_add_u32 v29, s52, v17
    v_add_u32 v30, s52, v18
    v_add_u32 v31, s52, v19
    v_add_u32 v4, s53, v24
    v_add_u32 v5, s53, v25
    v_add_u32 v6, s53, v26
    v_add_u32 v7, s53, v27
    s_barrier
    s_waitcnt lgkmcnt(6)
    v_cndmask_b32 v116, v116, v14, s[66:67]
    v_cndmask_b32 v117, v117, v14, s[66:67]
    v_cndmask_b32 v118, v118, v14, s[66:67]
    v_cndmask_b32 v119, v119, v14, s[66:67]
    s_nop 1
    v_mfma_f32_32x32x16_bf16 v[64:79], v[108:111], v[116:119], v[64:79]
    ds_read_b128 v[96:99], v28
    ds_read_b128 v[100:103], v28 offset:4096
    v_mul_f32 v38, s60, v38
    v_mul_f32 v39, s60, v39
    v_cvt_pk_bf16_f32 v144, v32, v33
    v_cvt_pk_bf16_f32 v145, v34, v35
    v_mfma_f32_32x32x16_bf16 v[80:95], v[112:115], v[116:119], v[80:95]
    ds_read_b128 v[104:107], v4
    v_cvt_pk_bf16_f32 v146, v36, v37
    v_cvt_pk_bf16_f32 v147, v38, v39
    buffer_store_dwordx4 v[144:147], v11, s[24:27], s59 offen sc1
    v_mul_f32 v40, s60, v40
    s_waitcnt lgkmcnt(6)
    v_cndmask_b32 v128, v128, v14, s[66:67]
    v_cndmask_b32 v129, v129, v14, s[66:67]
    v_cndmask_b32 v130, v130, v14, s[66:67]
    v_cndmask_b32 v131, v131, v14, s[66:67]
    s_nop 1
    v_mfma_f32_32x32x16_bf16 v[64:79], v[120:123], v[128:131], v[64:79]
    ds_read_b128 v[108:111], v29
    ds_read_b128 v[112:115], v29 offset:4096
    v_mul_f32 v41, s60, v41
    v_mul_f32 v42, s60, v42
    v_mul_f32 v43, s60, v43
    v_mul_f32 v44, s60, v44
    v_mfma_f32_32x32x16_bf16 v[80:95], v[124:127], v[128:131], v[80:95]
    ds_read_b128 v[116:119], v5
    v_mul_f32 v45, s60, v45
    v_mul_f32 v46, s60, v46
    v_mul_f32 v47, s60, v47
    v_cvt_pk_bf16_f32 v148, v40, v41
    s_waitcnt lgkmcnt(6)
    v_cndmask_b32 v140, v140, v14, s[66:67]
    v_cndmask_b32 v141, v141, v14, s[66:67]
    v_cndmask_b32 v142, v142, v14, s[66:67]
    v_cndmask_b32 v143, v143, v14, s[66:67]
    s_nop 1
    v_mfma_f32_32x32x16_bf16 v[64:79], v[132:135], v[140:143], v[64:79]
    ds_read_b128 v[120:123], v30
    ds_read_b128 v[124:127], v30 offset:4096
    v_cvt_pk_bf16_f32 v149, v42, v43
    v_cvt_pk_bf16_f32 v150, v44, v45
    v_cvt_pk_bf16_f32 v151, v46, v47
    buffer_store_dwordx4 v[148:151], v11, s[24:27], s68 offen sc1
    v_mfma_f32_32x32x16_bf16 v[80:95], v[136:139], v[140:143], v[80:95]
    ds_read_b128 v[128:131], v6
    s_add_u32 s50, s50, 1
    s_waitcnt lgkmcnt(6)
    v_cndmask_b32 v104, v104, v14, s[66:67]
    v_cndmask_b32 v105, v105, v14, s[66:67]
    v_cndmask_b32 v106, v106, v14, s[66:67]
    v_cndmask_b32 v107, v107, v14, s[66:67]
    s_nop 1
    v_mfma_f32_32x32x16_bf16 v[64:79], v[96:99], v[104:107], v[64:79]
    ds_read_b128 v[132:135], v31
    ds_read_b128 v[136:139], v31 offset:4096
    v_mul_f32 v48, s60, v48
    v_mul_f32 v49, s60, v49
    v_mul_f32 v50, s60, v50
    v_mul_f32 v51, s60, v51
    v_mfma_f32_32x32x16_bf16 v[80:95], v[100:103], v[104:107], v[80:95]
    ds_read_b128 v[140:143], v7
    v_mul_f32 v52, s60, v52
    v_mul_f32 v53, s60, v53
    v_mul_f32 v54, s60, v54
    v_mul_f32 v55, s60, v55
    s_add_u32 s51, s50, 1
    s_and_b32 s52, s51, 7
    s_lshl_b32 s52, s52, 14
    s_and_b32 s53, s51, 3
    s_lshl_b32 s53, s53, 13
    s_add_u32 s53, s53, 131072
    v_add_u32 v28, s52, v16
    v_add_u32 v29, s52, v17
    v_add_u32 v30, s52, v18
    v_add_u32 v31, s52, v19
    v_add_u32 v4, s53, v24
    v_add_u32 v5, s53, v25
    v_add_u32 v6, s53, v26
    v_add_u32 v7, s53, v27
    s_barrier
    s_waitcnt lgkmcnt(6)
    v_cndmask_b32 v116, v116, v14, s[66:67]
    v_cndmask_b32 v117, v117, v14, s[66:67]
    v_cndmask_b32 v118, v118, v14, s[66:67]
    v_cndmask_b32 v119, v119, v14, s[66:67]
    s_nop 1
    v_mfma_f32_32x32x16_bf16 v[64:79], v[108:111], v[116:119], v[64:79]
    ds_read_b128 v[96:99], v28
    ds_read_b128 v[100:103], v28 offset:4096
    v_cvt_pk_bf16_f32 v152, v48, v49
    v_cvt_pk_bf16_f32 v153, v50, v51
    v_cvt_pk_bf16_f32 v154, v52, v53
    v_cvt_pk_bf16_f32 v155, v54, v55
    v_mfma_f32_32x32x16_bf16 v[80:95], v[112:115], v[116:119], v[80:95]
    ds_read_b128 v[104:107], v4
    buffer_store_dwordx4 v[152:155], v11, s[24:27], s69 offen sc1
    v_mul_f32 v56, s60, v56
    v_mul_f32 v57, s60, v57
    v_mul_f32 v58, s60, v58
    s_waitcnt lgkmcnt(6)
    v_cndmask_b32 v128, v128, v14, s[66:67]
    v_cndmask_b32 v129, v129, v14, s[66:67]
    v_cndmask_b32 v130, v130, v14, s[66:67]
    v_cndmask_b32 v131, v131, v14, s[66:67]
    s_nop 1
    v_mfma_f32_32x32x16_bf16 v[64:79], v[120:123], v[128:131], v[64:79]
    ds_read_b128 v[108:111], v29
    ds_read_b128 v[112:115], v29 offset:4096
    v_mul_f32 v59, s60, v59
    v_mul_f32 v60, s60, v60
    v_mul_f32 v61, s60, v61
    v_mul_f32 v62, s60, v62
    v_mfma_f32_32x32x16_bf16 v[80:95], v[124:127], v[128:131], v[80:95]
    ds_read_b128 v[116:119], v5
    v_mul_f32 v63, s60, v63
    v_cvt_pk_bf16_f32 v156, v56, v57
    v_cvt_pk_bf16_f32 v157, v58, v59
    v_cvt_pk_bf16_f32 v158, v60, v61
    s_waitcnt lgkmcnt(6)
    v_cndmask_b32 v140, v140, v14, s[66:67]
    v_cndmask_b32 v141, v141, v14, s[66:67]
    v_cndmask_b32 v142, v142, v14, s[66:67]
    v_cndmask_b32 v143, v143, v14, s[66:67]
    s_nop 1
    v_mfma_f32_32x32x16_bf16 v[64:79], v[132:135], v[140:143], v[64:79]
    ds_read_b128 v[120:123], v30
    ds_read_b128 v[124:127], v30 offset:4096
    v_cvt_pk_bf16_f32 v159, v62, v63
    buffer_store_dwordx4 v[156:159], v11, s[24:27], s70 offen sc1
    v_mfma_f32_32x32x16_bf16 v[80:95], v[136:139], v[140:143], v[80:95]
    ds_read_b128 v[128:131], v6
    s_add_u32 s50, s50, 1
L_k1_qkv_kernel_p2F:
    s_waitcnt lgkmcnt(6)
    v_cndmask_b32 v104, v104, v14, s[66:67]
    v_cndmask_b32 v105, v105, v14, s[66:67]
    v_cndmask_b32 v106, v106, v14, s[66:67]
    v_cndmask_b32 v107, v107, v14, s[66:67]
    s_nop 1
    v_mfma_f32_32x32x16_bf16 v[64:79], v[96:99], v[104:107], v[64:79]
    ds_read_b128 v[132:135], v31
    ds_read_b128 v[136:139], v31 offset:4096
    v_mfma_f32_32x32x16_bf16 v[80:95], v[100:103], v[104:107], v[80:95]
    ds_read_b128 v[140:143], v7
    s_add_u32 s51, s50, 1
    s_and_b32 s52, s51, 7
    s_lshl_b32 s52, s52, 14
    s_and_b32 s53, s51, 3
    s_lshl_b32 s53, s53, 13
    s_add_u32 s53, s53, 131072
    v_add_u32 v28, s52, v16
    v_add_u32 v29, s52, v17
    v_add_u32 v30, s52, v18
    v_add_u32 v31, s52, v19
    v_add_u32 v4, s53, v24
    v_add_u32 v5, s53, v25
    v_add_u32 v6, s53, v26
    v_add_u32 v7, s53, v27
    s_barrier
    s_waitcnt lgkmcnt(6)
    v_cndmask_b32 v116, v116, v14, s[66:67]
    v_cndmask_b32 v117, v117, v14, s[66:67]
    v_cndmask_b32 v118, v118, v14, s[66:67]
    v_cndmask_b32 v119, v119, v14, s[66:67]
    s_nop 1
    v_mfma_f32_32x32x16_bf16 v[64:79], v[108:111], v[116:119], v[64:79]
    ds_read_b128 v[96:99], v28
    ds_read_b128 v[100:103], v28 offset:4096
    v_mfma_f32_32x32x16_bf16 v[80:95], v[112:115], v[116:119], v[80:95]
    ds_read_b128 v[104:107], v4
    s_waitcnt lgkmcnt(6)
    v_cndmask_b32 v128, v128, v14, s[66:67]
    v_cndmask_b32 v129, v129, v14, s[66:67]
    v_cndmask_b32 v130, v130, v14, s[66:67]
    v_cndmask_b32 v131, v131, v14, s[66:67]
    s_nop 1
    v_mfma_f32_32x32x16_bf16 v[64:79], v[120:123], v[128:131], v[64:79]
    ds_read_b128 v[108:111], v29
    ds_read_b128 v[112:115], v29 offset:4096
    v_mfma_f32_32x32x16_bf16 v[80:95], v[124:127], v[128:131], v[80:95]
    ds_read_b128 v[116:119], v5
    s_waitcnt lgkmcnt(6)
    v_cndmask_b32 v140, v140, v14, s[66:67]
    v_cndmask_b32 v141, v141, v14, s[66:67]
    v_cndmask_b32 v142, v142, v14, s[66:67]
    v_cndmask_b32 v143, v143, v14, s[66:67]
    s_nop 1
    v_mfma_f32_32x32x16_bf16 v[64:79], v[132:135], v[140:143], v[64:79]
    ds_read_b128 v[120:123], v30
    ds_read_b128 v[124:127], v30 offset:4096
    v_mfma_f32_32x32x16_bf16 v[80:95], v[136:139], v[140:143], v[80:95]
    ds_read_b128 v[128:131], v6
    s_add_u32 s50, s50, 1
    s_cmp_lt_u32 s50, 15
    s_cbranch_scc1 L_k1_qkv_kernel_p2F
    s_waitcnt lgkmcnt(6)
    v_cndmask_b32 v104, v104, v14, s[66:67]
    v_cndmask_b32 v105, v105, v14, s[66:67]
    v_cndmask_b32 v106, v106, v14, s[66:67]
    v_cndmask_b32 v107, v107, v14, s[66:67]
    s_nop 1
    v_mfma_f32_32x32x16_bf16 v[64:79], v[96:99], v[104:107], v[64:79]
    ds_read_b128 v[132:135], v31
    ds_read_b128 v[136:139], v31 offset:4096
    v_mfma_f32_32x32x16_bf16 v[80:95], v[100:103], v[104:107], v[80:95]
    ds_read_b128 v[140:143], v7
    s_waitcnt lgkmcnt(6)
    v_cndmask_b32 v116, v116, v14, s[66:67]
    v_cndmask_b32 v117, v117, v14, s[66:67]
    v_cndmask_b32 v118, v118, v14, s[66:67]
    v_cndmask_b32 v119, v119, v14, s[66:67]
    s_nop 1
    v_mfma_f32_32x32x16_bf16 v[64:79], v[108:111], v[116:119], v[64:79]
    v_mfma_f32_32x32x16_bf16 v[80:95], v[112:115], v[116:119], v[80:95]
    s_waitcnt lgkmcnt(3)
    v_cndmask_b32 v128, v128, v14, s[66:67]
    v_cndmask_b32 v129, v129, v14, s[66:67]
    v_cndmask_b32 v130, v130, v14, s[66:67]
    v_cndmask_b32 v131, v131, v14, s[66:67]
    s_nop 1
    v_mfma_f32_32x32x16_bf16 v[64:79], v[120:123], v[128:131], v[64:79]
    v_mfma_f32_32x32x16_bf16 v[80:95], v[124:127], v[128:131], v[80:95]
    s_waitcnt lgkmcnt(0)
    v_cndmask_b32 v140, v140, v14, s[66:67]
    v_cndmask_b32 v141, v141, v14, s[66:67]
    v_cndmask_b32 v142, v142, v14, s[66:67]
    v_cndmask_b32 v143, v143, v14, s[66:67]
    s_nop 1
    v_mfma_f32_32x32x16_bf16 v[64:79], v[132:135], v[140:143], v[64:79]
    v_mfma_f32_32x32x16_bf16 v[80:95], v[136:139], v[140:143], v[80:95]
    s_add_u32 s50, s50, 1
    s_nop 15
    v_mov_b32 v12, -1.0
    v_mov_b32 v13, 1.0
    v_cmp_gt_u32 vcc, 16, v8
    s_nop 1
    v_cndmask_b32 v12, v12, v13, vcc
    v_cndmask_b32 v12, v12, v13, s[66:67]
    s_cmp_eq_u32 s54, 0
    s_cselect_b32 s68, -1, 0
    s_mov_b32 s69, 0
    v_mov_b32 v15, v80
    v_mov_b32 v13, 0
    v_cndmask_b32 v80, v80, v13, s[68:69]
    v_fma_f32 v64, v80, v12, v64
    v_fma_f32 v65, v81, v12, v65
    v_fma_f32 v66, v82, v12, v66
    v_fma_f32 v67, v83, v12, v67
    v_fma_f32 v68, v84, v12, v68
    v_fma_f32 v69, v85, v12, v69
    v_fma_f32 v70, v86, v12, v70
    v_fma_f32 v71, v87, v12, v71
    v_fma_f32 v72, v88, v12, v72
    v_fma_f32 v73, v89, v12, v73
    v_fma_f32 v74, v90, v12, v74
    v_fma_f32 v75, v91, v12, v75
    v_fma_f32 v76, v92, v12, v76
    v_fma_f32 v77, v93, v12, v77
    v_fma_f32 v78, v94, v12, v78
    v_fma_f32 v79, v95, v12, v79
    v_lshlrev_b32 v11, 4, v1
    s_mul_i32 s63, s35, 5120
    s_add_u32 s63, s63, 0
    v_add_u32 v16, s63, v11
    s_xor_b32 s63, s35, 1
    s_mul_i32 s63, s63, 5120
    s_add_u32 s63, s63, 0
    v_add_u32 v17, s63, v11
    ds_write_b128 v16, v[64:67] offset:0
    ds_write_b128 v16, v[68:71] offset:1024
    ds_write_b128 v16, v[72:75] offset:2048
    ds_write_b128 v16, v[76:79] offset:3072
    v_lshlrev_b32 v18, 2, v1
    s_mul_i32 s63, s35, 5120
    s_add_u32 s63, s63, 4096
    v_add_u32 v18, s63, v18
    ds_write_b32 v18, v15
    s_waitcnt lgkmcnt(0)
    s_barrier
    ds_read_b128 v[112:115], v17 offset:0
    ds_read_b128 v[116:119], v17 offset:1024
    ds_read_b128 v[120:123], v17 offset:2048
    ds_read_b128 v[124:127], v17 offset:3072
    v_lshlrev_b32 v18, 2, v1
    s_xor_b32 s63, s35, 1
    s_mul_i32 s63, s63, 5120
    s_add_u32 s63, s63, 4096
    v_add_u32 v18, s63, v18
    ds_read_b32 v14, v18
    s_waitcnt lgkmcnt(0)
    s_cmp_eq_u32 s35, 0
    s_cbranch_scc0 L_k1_qkv_kernel_odd
    v_fma_f32 v64, v112, v12, v64
    v_fma_f32 v65, v113, v12, v65
    v_fma_f32 v66, v114, v12, v66
    v_fma_f32 v67, v115, v12, v67
    v_fma_f32 v68, v116, v12, v68
    v_fma_f32 v69, v117, v12, v69
    v_fma_f32 v70, v118, v12, v70
    v_fma_f32 v71, v119, v12, v71
    v_fma_f32 v72, v120, v12, v72
    v_fma_f32 v73, v121, v12, v73
    v_fma_f32 v74, v122, v12, v74
    v_fma_f32 v75, v123, v12, v75
    v_fma_f32 v76, v124, v12, v76
    v_fma_f32 v77, v125, v12, v77
    v_fma_f32 v78, v126, v12, v78
    v_fma_f32 v79, v127, v12, v79
    v_fma_f32 v15, v14, v12, v15
    s_branch L_k1_qkv_kernel_oddd
L_k1_qkv_kernel_odd:
    v_sub_f32 v13, 0, v12
    v_fma_f32 v64, v64, v13, v112
    v_fma_f32 v65, v65, v13, v113
    v_fma_f32 v66, v66, v13, v114
    v_fma_f32 v67, v67, v13, v115
    v_fma_f32 v68, v68, v13, v116
    v_fma_f32 v69, v69, v13, v117
    v_fma_f32 v70, v70, v13, v118
    v_fma_f32 v71, v71, v13, v119
    v_fma_f32 v72, v72, v13, v120
    v_fma_f32 v73, v73, v13, v121
    v_fma_f32 v74, v74, v13, v122
    v_fma_f32 v75, v75, v13, v123
    v_fma_f32 v76, v76, v13, v124
    v_fma_f32 v77, v77, v13, v125
    v_fma_f32 v78, v78, v13, v126
    v_fma_f32 v79, v79, v13, v127
    v_fma_f32 v15, v15, v12, v14
L_k1_qkv_kernel_oddd:
    v_cvt_pk_bf16_f32 v144, v64, v65
    v_cvt_pk_bf16_f32 v145, v66, v67
    v_cvt_pk_bf16_f32 v146, v68, v69
    v_cvt_pk_bf16_f32 v147, v70, v71
    v_cvt_pk_bf16_f32 v148, v72, v73
    v_cvt_pk_bf16_f32 v149, v74, v75
    v_cvt_pk_bf16_f32 v150, v76, v77
    v_cvt_pk_bf16_f32 v151, v78, v79
    s_lshr_b32 s57, s55, 1
    s_mul_i32 s58, s57, 33792
    s_mul_i32 s59, s35, 655360
    s_add_u32 s58, s58, s59
    s_add_u32 s58, s58, 10485760
    s_add_u32 s60, s58, 327680
    s_and_b32 s62, s55, 1
    s_lshl_b32 s62, s62, 8
    v_and_b32 v16, 15, v8
    v_lshlrev_b32 v16, 4, v16
    v_lshl_add_u32 v16, v9, 9, v16
    v_add_u32 v16, s62, v16
    v_mov_b32 v17, s60
    v_mov_b32 v18, s58
    v_cmp_gt_u32 vcc, 16, v8
    s_nop 1
    v_cndmask_b32 v17, v17, v18, vcc
    v_add_u32 v17, v17, v16
    s_add_u32 s59, s59, 10756096
    v_mov_b32 v18, s59
    v_lshl_add_u32 v18, v9, 9, v18
    v_cndmask_b32 v19, v17, v18, s[66:67]
    s_lshl_b32 s63, s54, 11
    buffer_store_dwordx4 v[144:147], v19, s[24:27], s63 offen offset:0 sc1
    buffer_store_dwordx4 v[148:151], v19, s[24:27], s63 offen offset:1024 sc1
    s_cmp_eq_u32 s55, 0
    s_cbranch_scc0 L_k1_qkv_kernel_nz
    v_mov_b32 v104, 0
    v_mov_b32 v105, 0
    v_mov_b32 v106, 0
    v_mov_b32 v107, 0
    s_mov_b64 exec, s[66:67]
    buffer_store_dwordx4 v[104:107], v17, s[24:27], s63 offen offset:0 sc1
    buffer_store_dwordx4 v[104:107], v17, s[24:27], s63 offen offset:1024 sc1
    s_mov_b32 s64, 32768
    buffer_store_dwordx4 v[104:107], v17, s[24:27], s64 offen sc1
    s_mov_b64 exec, -1
L_k1_qkv_kernel_nz:
    s_cmp_eq_u32 s54, 0
    s_cbranch_scc0 L_k1_qkv_kernel_fin
    v_mov_b32 v13, 0
    v_cndmask_b32 v15, v13, v15, s[68:69]
    v_cvt_pk_bf16_f32 v108, v15, v13
    v_mov_b32 v109, 0
    v_mov_b32 v110, 0
    v_mov_b32 v111, 0
    s_mov_b32 s70, 0x0000ffff
    s_mov_b32 s71, 0x0000ffff
    s_or_b64 s[70:71], s[70:71], s[66:67]
    s_not_b64 s[72:73], s[70:71]
    s_cmp_eq_u32 s35, 0
    s_cselect_b64 s[70:71], s[70:71], s[72:73]
    s_mov_b64 exec, s[70:71]
    s_mov_b32 s63, 32768
    buffer_store_dwordx4 v[108:111], v19, s[24:27], s63 offen sc1
    s_mov_b64 exec, -1
L_k1_qkv_kernel_fin:
L_k1_qkv_kernel_end:
    s_endpgm
.globl k2_attn_kernel
.p2align 8
.type k2_attn_kernel,@function
k2_attn_kernel:
    s_cmp_ge_u32 s2, 256
    s_cbranch_scc1 L_k2_attn_kernel_end
    s_load_dwordx4 s[36:39], s[0:1], 8
    s_load_dwordx2 s[46:47], s[0:1], 88
    s_load_dwordx2 s[56:57], s[0:1], 56
    s_load_dwordx2 s[72:73], s[0:1], 72
    v_lshrrev_b32 v2, 6, v0
    v_and_b32 v1, 63, v0
    v_readfirstlane_b32 s32, v2
    v_lshlrev_b32 v2, 4, v1
    s_and_b32 s33, s2, 7
    s_lshr_b32 s34, s2, 3
    s_and_b32 s35, s34, 3
    s_lshl_b32 s40, s33, 2
    s_add_u32 s40, s40, s35
    s_lshr_b32 s41, s2, 5
    s_waitcnt lgkmcnt(0)
    s_mov_b32 s24, s46
    s_mov_b32 s25, s47
    s_mov_b32 s26, 0xd00000
    s_mov_b32 s27, 0x20000
    s_cmp_ge_u32 s32, 8
    s_cbranch_scc1 L_k2_attn_kernel_fnet
    s_lshl_b32 s42, s41, 3
    s_add_u32 s42, s42, s32
    s_lshl_b32 s43, s40, 16
    s_lshl_b32 s44, s42, 10
    s_add_u32 s43, s43, s44
    buffer_load_dwordx4 v[4:7], v2, s[24:27], s43 offen
    s_lshl_b32 s43, s40, 17
    s_add_u32 s43, s43, 2097152
    s_lshl_b32 s44, s32, 11
    s_mov_b32 s46, s32
    s_add_u32 m0, s44, 0
    s_and_b32 s46, s46, 63
    s_lshl_b32 s45, s46, 11
    s_add_u32 s45, s45, s43
    buffer_load_dwordx4 v2, s[24:27], s45 offen lds
    buffer_load_dwordx4 v2, s[24:27], s45 offen offset:1024 lds
    s_add_u32 s46, s46, 8
    s_add_u32 m0, s44, 16384
    s_and_b32 s46, s46, 63
    s_lshl_b32 s45, s46, 11
    s_add_u32 s45, s45, s43
    buffer_load_dwordx4 v2, s[24:27], s45 offen lds
    buffer_load_dwordx4 v2, s[24:27], s45 offen offset:1024 lds
    s_add_u32 s46, s46, 8
    s_add_u32 m0, s44, 32768
    s_and_b32 s46, s46, 63
    s_lshl_b32 s45, s46, 11
    s_add_u32 s45, s45, s43
    buffer_load_dwordx4 v2, s[24:27], s45 offen lds
    buffer_load_dwordx4 v2, s[24:27], s45 offen offset:1024 lds
    s_add_u32 s46, s46, 8
    s_add_u32 m0, s44, 49152
    s_and_b32 s46, s46, 63
    s_lshl_b32 s45, s46, 11
    s_add_u32 s45, s45, s43
    buffer_load_dwordx4 v2, s[24:27], s45 offen lds
    buffer_load_dwordx4 v2, s[24:27], s45 offen offset:1024 lds
    s_add_u32 s46, s46, 8
    s_add_u32 m0, s44, 65536
    s_and_b32 s46, s46, 63
    s_lshl_b32 s45, s46, 11
    s_add_u32 s45, s45, s43
    buffer_load_dwordx4 v2, s[24:27], s45 offen lds
    buffer_load_dwordx4 v2, s[24:27], s45 offen offset:1024 lds
    s_add_u32 s46, s46, 8
    s_add_u32 m0, s44, 81920
    s_and_b32 s46, s46, 63
    s_lshl_b32 s45, s46, 11
    s_add_u32 s45, s45, s43
    buffer_load_dwordx4 v2, s[24:27], s45 offen lds
    buffer_load_dwordx4 v2, s[24:27], s45 offen offset:1024 lds
    s_add_u32 s46, s46, 8
    s_add_u32 m0, s44, 98304
    s_and_b32 s46, s46, 63
    s_lshl_b32 s45, s46, 11
    s_add_u32 s45, s45, s43
    buffer_load_dwordx4 v2, s[24:27], s45 offen lds
    buffer_load_dwordx4 v2, s[24:27], s45 offen offset:1024 lds
    s_add_u32 s46, s46, 8
    s_add_u32 m0, s44, 114688
    s_and_b32 s46, s46, 63
    s_lshl_b32 s45, s46, 11
    s_add_u32 s45, s45, s43
    buffer_load_dwordx4 v2, s[24:27], s45 offen lds
    buffer_load_dwordx4 v2, s[24:27], s45 offen offset:1024 lds
    s_add_u32 s46, s46, 8
    v_mov_b32 v3, 0xdddddddd
    v_mov_b32 v97, 0
    v_mov_b32 v98, 0x3f803f80
    s_mov_b32 s52, 0x00110000
    s_mov_b32 s53, 0x00110000
    v_cndmask_b32 v97, v97, v98, s[52:53]
    v_mov_b32 v80, v97
    v_mov_b32 v81, v97
    v_mov_b32 v82, v97
    v_mov_b32 v83, v97
    v_mov_b32 v84, v97
    v_mov_b32 v85, v97
    v_mov_b32 v86, v97
    v_mov_b32 v87, v97
    v_mov_b32 v88, v97
    v_mov_b32 v89, v97
    v_mov_b32 v90, v97
    v_mov_b32 v91, v97
    v_mov_b32 v92, v97
    v_mov_b32 v93, v97
    v_mov_b32 v94, v97
    v_mov_b32 v95, v97
    s_mov_b32 s48, 0x0000ffff
    s_mov_b32 s49, 0x0000ffff
    s_mov_b32 s50, 0
    s_cmp_lt_u32 s32, 4
    s_cselect_b32 s54, 10, 12
    s_cselect_b32 s55, 15, 63
    s_cselect_b32 s58, 2, 99
    s_setprio 3
    v_mov_b32 v56, 0
    v_mov_b32 v57, 0
    v_mov_b32 v58, 0
    v_mov_b32 v59, 0
    v_mov_b32 v60, 0
    v_mov_b32 v61, 0
    v_mov_b32 v62, 0
    v_mov_b32 v63, 0
    v_mov_b32 v64, 0
    v_mov_b32 v65, 0
    v_mov_b32 v66, 0
    v_mov_b32 v67, 0
    v_mov_b32 v68, 0
    v_mov_b32 v69, 0
    v_mov_b32 v70, 0
    v_mov_b32 v71, 0
    v_mov_b32 v48, 0
    v_mov_b32 v49, 0
    v_mov_b32 v50, 0
    v_mov_b32 v51, 0
    v_mov_b32 v52, 0
    v_mov_b32 v53, 0
    v_mov_b32 v54, 0
    v_mov_b32 v55, 0
    v_mov_b32 v96, v2
    s_waitcnt vmcnt(12)
    s_barrier
    ds_read_b128 v[72:75], v2
    ds_read_b128 v[76:79], v2 offset:2048
    s_mov_b64 exec, s[48:49]
    ds_read_b128 v[80:83], v2 offset:1024
    ds_read_b128 v[84:87], v2 offset:1280
    s_mov_b64 exec, -1
    s_waitcnt lgkmcnt(3)
    v_mfma_f32_32x32x16_bf16 v[24:39], v[72:75], v[4:7], 0
    s_nop 15
    v_max3_f32 v97, v24, v25, v26
    v_max3_f32 v97, v97, v27, v28
    v_max3_f32 v97, v97, v29, v30
    v_max3_f32 v97, v97, v31, v32
    v_max3_f32 v97, v97, v33, v34
    v_max3_f32 v97, v97, v35, v36
    v_max3_f32 v97, v97, v37, v38
    v_max_f32 v97, v97, v39
L_k2_attn_kernel_havemax:
    v_mov_b32 v98, v97
    s_nop 1
    v_permlane32_swap_b32 v97, v98
    s_nop 1
    v_max_f32 v97, v97, v98
    v_sub_f32 v8, 0, v97
    v_sub_f32 v9, 0, v97
    v_sub_f32 v10, 0, v97
    v_sub_f32 v11, 0, v97
    v_sub_f32 v12, 0, v97
    v_sub_f32 v13, 0, v97
    v_sub_f32 v14, 0, v97
    v_sub_f32 v15, 0, v97
    v_sub_f32 v16, 0, v97
    v_sub_f32 v17, 0, v97
    v_sub_f32 v18, 0, v97
    v_sub_f32 v19, 0, v97
    v_sub_f32 v20, 0, v97
    v_sub_f32 v21, 0, v97
    v_sub_f32 v22, 0, v97
    v_sub_f32 v23, 0, v97
    s_waitcnt lgkmcnt(0)
    v_mfma_f32_32x32x16_bf16 v[24:39], v[72:75], v[4:7], v[8:23]
    s_mov_b32 s51, 0
    s_nop 15
.p2align 6
L_k2_attn_kernel_loop:
    s_waitcnt lgkmcnt(0)
    v_exp_f32 v24, v24
    v_exp_f32 v25, v25
    v_smfmac_f32_32x32x32_bf16 v[56:71], v[92:95], v[48:55], v3
    ds_read_b128 v[72:75], v96 offset:4096
    s_mov_b64 exec, s[48:49]
    ds_read_b128 v[88:91], v96 offset:3072
    ds_read_b128 v[92:95], v96 offset:3328
    s_mov_b64 exec, -1
    v_exp_f32 v26, v26
    v_exp_f32 v27, v27
    v_exp_f32 v28, v28
    v_exp_f32 v29, v29
    v_exp_f32 v30, v30
    v_mfma_f32_32x32x16_bf16 v[40:55], v[76:79], v[4:7], v[8:23]
    v_exp_f32 v31, v31
    v_exp_f32 v32, v32
    v_exp_f32 v33, v33
    v_exp_f32 v34, v34
    v_exp_f32 v35, v35
    v_smfmac_f32_32x32x32_bf16 v[56:71], v[80:83], v[24:31], v3
    v_exp_f32 v36, v36
    v_exp_f32 v37, v37
    v_exp_f32 v38, v38
    v_exp_f32 v39, v39
    s_waitcnt lgkmcnt(0)
    v_exp_f32 v40, v40
    v_exp_f32 v41, v41
    v_smfmac_f32_32x32x32_bf16 v[56:71], v[84:87], v[32:39], v3
    ds_read_b128 v[76:79], v96 offset:6144
    s_mov_b64 exec, s[48:49]
    ds_read_b128 v[80:83], v96 offset:5120
    ds_read_b128 v[84:87], v96 offset:5376
    s_mov_b64 exec, -1
    v_exp_f32 v42, v42
    v_exp_f32 v43, v43
    v_exp_f32 v44, v44
    v_exp_f32 v45, v45
    v_exp_f32 v46, v46
    v_mfma_f32_32x32x16_bf16 v[24:39], v[72:75], v[4:7], v[8:23]
    v_exp_f32 v47, v47
    v_exp_f32 v48, v48
    v_exp_f32 v49, v49
    v_exp_f32 v50, v50
    v_exp_f32 v51, v51
    v_smfmac_f32_32x32x32_bf16 v[56:71], v[88:91], v[40:47], v3
    v_exp_f32 v52, v52
    v_exp_f32 v53, v53
    v_exp_f32 v54, v54
    v_exp_f32 v55, v55
    s_waitcnt lgkmcnt(0)
    v_exp_f32 v24, v24
    v_exp_f32 v25, v25
    v_smfmac_f32_32x32x32_bf16 v[56:71], v[92:95], v[48:55], v3
    ds_read_b128 v[72:75], v96 offset:8192
    s_mov_b64 exec, s[48:49]
    ds_read_b128 v[88:91], v96 offset:7168
    ds_read_b128 v[92:95], v96 offset:7424
    s_mov_b64 exec, -1
    v_exp_f32 v26, v26
    v_exp_f32 v27, v27
    v_exp_f32 v28, v28
    v_exp_f32 v29, v29
    v_exp_f32 v30, v30
    v_mfma_f32_32x32x16_bf16 v[40:55], v[76:79], v[4:7], v[8:23]
    v_exp_f32 v31, v31
    v_exp_f32 v32, v32
    v_exp_f32 v33, v33
    v_exp_f32 v34, v34
    v_exp_f32 v35, v35
    v_smfmac_f32_32x32x32_bf16 v[56:71], v[80:83], v[24:31], v3
    v_exp_f32 v36, v36
    v_exp_f32 v37, v37
    v_exp_f32 v38, v38
    v_exp_f32 v39, v39
    s_waitcnt lgkmcnt(0)
    v_exp_f32 v40, v40
    v_exp_f32 v41, v41
    v_smfmac_f32_32x32x32_bf16 v[56:71], v[84:87], v[32:39], v3
    ds_read_b128 v[76:79], v96 offset:10240
    s_mov_b64 exec, s[48:49]
    ds_read_b128 v[80:83], v96 offset:9216
    ds_read_b128 v[84:87], v96 offset:9472
    s_mov_b64 exec, -1
    v_exp_f32 v42, v42
    v_exp_f32 v43, v43
    v_exp_f32 v44, v44
    v_exp_f32 v45, v45
    v_exp_f32 v46, v46
    v_mfma_f32_32x32x16_bf16 v[24:39], v[72:75], v[4:7], v[8:23]
    v_exp_f32 v47, v47
    v_exp_f32 v48, v48
    v_exp_f32 v49, v49
    v_exp_f32 v50, v50
    v_exp_f32 v51, v51
    v_smfmac_f32_32x32x32_bf16 v[56:71], v[88:91], v[40:47], v3
    v_exp_f32 v52, v52
    v_exp_f32 v53, v53
    v_exp_f32 v54, v54
    v_exp_f32 v55, v55
    v_add_u32 v96, 8192, v96
    s_add_u32 s51, s51, 1
    s_cmp_eq_u32 s51, s58
    s_cbranch_scc1 L_k2_attn_kernel_ev2
    s_cmp_eq_u32 s51, 3
    s_cbranch_scc1 L_k2_attn_kernel_ev3
    s_cmp_eq_u32 s51, s54
    s_cbranch_scc1 L_k2_attn_kernel_ev10
    s_cmp_eq_u32 s51, s55
    s_cbranch_scc1 L_k2_attn_kernel_ev14
    s_cmp_lt_u32 s51, 16
    s_cbranch_scc1 L_k2_attn_kernel_loop
    s_branch L_k2_attn_kernel_done
L_k2_attn_kernel_ev1:
    s_cmp_eq_u32 s50, 0
    s_cbranch_scc0 L_k2_attn_kernel_loop
    s_waitcnt vmcnt(12)
    s_barrier
    s_branch L_k2_attn_kernel_loop
L_k2_attn_kernel_ev2:
    s_setprio 2
    s_branch L_k2_attn_kernel_loop
L_k2_attn_kernel_ev3:
    s_setprio 2
    s_cmp_eq_u32 s50, 0
    s_cbranch_scc0 L_k2_attn_kernel_loop
    s_waitcnt vmcnt(0)
    s_barrier
    s_branch L_k2_attn_kernel_loop
L_k2_attn_kernel_ev10:
    s_setprio 1
    s_branch L_k2_attn_kernel_loop
L_k2_attn_kernel_ev14:
    s_setprio 0
    s_branch L_k2_attn_kernel_loop
L_k2_attn_kernel_done:
    s_nop 1
    v_smfmac_f32_32x32x32_bf16 v[56:71], v[92:95], v[48:55], v3
    s_waitcnt lgkmcnt(0)
    s_nop 15
    s_mov_b32 s52, 0x5d800000
    v_cmp_gt_f32 vcc, s52, v64
    s_nop 3
    s_cmp_eq_u64 vcc, -1
    s_cbranch_scc1 L_k2_attn_kernel_ok
    s_cmp_eq_u32 s50, 0
    s_cbranch_scc0 L_k2_attn_kernel_ok
    s_mov_b32 s50, 1
    s_setprio 2
    v_mov_b32 v97, 0xff800000
    v_mov_b32 v96, v2
    s_mov_b32 s51, 0
L_k2_attn_kernel_fb:
    ds_read_b128 v[72:75], v96
    s_waitcnt lgkmcnt(0)
    v_mfma_f32_32x32x16_bf16 v[24:39], v[72:75], v[4:7], 0
    s_nop 15
    v_max3_f32 v97, v97, v24, v25
    v_max3_f32 v97, v97, v26, v27
    v_max3_f32 v97, v97, v28, v29
    v_max3_f32 v97, v97, v30, v31
    v_max3_f32 v97, v97, v32, v33
    v_max3_f32 v97, v97, v34, v35
    v_max3_f32 v97, v97, v36, v37
    v_max3_f32 v97, v97, v38, v39
    v_add_u32 v96, 2048, v96
    s_add_u32 s51, s51, 1
    s_cmp_lt_u32 s51, 64
    s_cbranch_scc1 L_k2_attn_kernel_fb
    v_mov_b32 v56, 0
    v_mov_b32 v57, 0
    v_mov_b32 v58, 0
    v_mov_b32 v59, 0
    v_mov_b32 v60, 0
    v_mov_b32 v61, 0
    v_mov_b32 v62, 0
    v_mov_b32 v63, 0
    v_mov_b32 v64, 0
    v_mov_b32 v65, 0
    v_mov_b32 v66, 0
    v_mov_b32 v67, 0
    v_mov_b32 v68, 0
    v_mov_b32 v69, 0
    v_mov_b32 v70, 0
    v_mov_b32 v71, 0
    v_mov_b32 v48, 0
    v_mov_b32 v49, 0
    v_mov_b32 v50, 0
    v_mov_b32 v51, 0
    v_mov_b32 v52, 0
    v_mov_b32 v53, 0
    v_mov_b32 v54, 0
    v_mov_b32 v55, 0
    v_mov_b32 v96, v2
    ds_read_b128 v[72:75], v2
    ds_read_b128 v[76:79], v2 offset:2048
    s_mov_b64 exec, s[48:49]
    ds_read_b128 v[80:83], v2 offset:1024
    ds_read_b128 v[84:87], v2 offset:1280
    s_mov_b64 exec, -1
    s_branch L_k2_attn_kernel_havemax
L_k2_attn_kernel_ok:
    v_rcp_f32 v97, v64
    s_nop 0
    v_mul_f32 v56, v97, v56
    v_mul_f32 v57, v97, v57
    v_mul_f32 v58, v97, v58
    v_mul_f32 v59, v97, v59
    v_mul_f32 v60, v97, v60
    v_mul_f32 v61, v97, v61
    v_mul_f32 v62, v97, v62
    v_mul_f32 v63, v97, v63
    v_cvt_pk_bf16_f32 v100, v56, v57
    v_cvt_pk_bf16_f32 v101, v58, v59
    v_cvt_pk_bf16_f32 v102, v60, v61
    v_cvt_pk_bf16_f32 v103, v62, v63
    s_lshl_b32 s43, s42, 15
    s_lshl_b32 s44, s40, 10
    s_add_u32 s43, s43, s44
    s_add_u32 s43, s43, 6291456
    buffer_store_dwordx4 v[100:103], v2, s[24:27], s43 offen sc1
    s_waitcnt vmcnt(0)
    s_branch L_k2_attn_kernel_endB
L_k2_attn_kernel_fnet:
    s_setprio 3
    s_sub_u32 s35, s32, 8
    s_mov_b32 s8, s36
    s_mov_b32 s9, s37
    s_mov_b32 s10, 0x800000
    s_mov_b32 s11, 0x20000
    s_mov_b32 s12, s38
    s_mov_b32 s13, s39
    s_mov_b32 s14, 0x800000
    s_mov_b32 s15, 0x20000
    v_mov_b32 v4, 0
    v_mov_b32 v5, 0
    v_mov_b32 v6, 0
    v_mov_b32 v7, 0
    v_mov_b32 v8, 147456
    ds_write_b128 v8, v[4:7]
    s_waitcnt lgkmcnt(0)
    s_barrier
    v_and_b32 v9, 31, v1
    v_lshrrev_b32 v10, 5, v1
    s_mov_b32 s60, 0
    s_mov_b32 s61, 0
    s_lshr_b32 s62, s35, 1
    s_and_b32 s63, s35, 1
    s_cmp_eq_u32 s62, 0
    s_cselect_b32 s16, s8, s12
    s_cselect_b32 s17, s9, s13
    s_mov_b32 s18, 0x800000
    s_mov_b32 s19, 0x20000
L_k2_attn_kernel_job:
    s_cmp_eq_u32 s60, 0
    s_cbranch_scc1 L_k2_attn_kernel_dojob
    s_mov_b32 s16, s8
    s_mov_b32 s17, s9
    s_mov_b32 s62, 0
L_k2_attn_kernel_dojob:
    s_and_b32 s66, s40, 1
    s_lshr_b32 s42, s40, 1
    s_lshl_b32 s42, s42, 6
    s_add_u32 s42, s42, s66
    v_lshl_add_u32 v11, v9, 1, s42
    v_mov_b32 v8, v11
    v_lshlrev_b32 v11, 12, v11
    v_lshl_add_u32 v11, v10, 4, v11
    s_lshl_b32 s43, s66, 1
    s_add_u32 s43, s43, s62
    s_mul_i32 s43, s43, 327680
    s_mul_i32 s44, s41, 33792
    s_add_u32 s43, s43, s44
    s_add_u32 s43, s43, 10485760
    s_add_u32 s67, s43, 32768
    s_lshl_b32 s45, s63, 4
    s_lshl_b32 s46, s35, 3
    s_cmp_eq_u32 s60, 0
    s_cselect_b32 s49, s45, s46
    s_lshl_b32 s45, s49, 10
    s_add_u32 s43, s43, s45
    s_lshl_b32 s45, s49, 5
    v_mov_b32 v16, 0
    v_mov_b32 v17, 0
    v_mov_b32 v18, 0
    v_mov_b32 v19, 0
    v_mov_b32 v20, 0
    v_mov_b32 v21, 0
    v_mov_b32 v22, 0
    v_mov_b32 v23, 0
    v_mov_b32 v24, 0
    v_mov_b32 v25, 0
    v_mov_b32 v26, 0
    v_mov_b32 v27, 0
    v_mov_b32 v28, 0
    v_mov_b32 v29, 0
    v_mov_b32 v30, 0
    v_mov_b32 v31, 0
    s_cmp_eq_u32 s60, 0
    s_cselect_b32 s58, 1, 0
    s_and_b32 s59, s41, s58
    s_xor_b32 s64, s59, 0
    s_lshl_b32 s65, s64, 8
    s_add_u32 s65, s65, s45
    s_lshl_b32 s64, s64, 13
    s_add_u32 s64, s64, s43
    buffer_load_dwordx4 v[32:35], v11, s[16:19], s65 offen offset:0
    buffer_load_dwordx4 v[36:39], v2, s[24:27], s64 offen offset:0
    buffer_load_dwordx4 v[40:43], v11, s[16:19], s65 offen offset:32
    buffer_load_dwordx4 v[44:47], v2, s[24:27], s64 offen offset:1024
    buffer_load_dwordx4 v[48:51], v11, s[16:19], s65 offen offset:64
    buffer_load_dwordx4 v[52:55], v2, s[24:27], s64 offen offset:2048
    buffer_load_dwordx4 v[56:59], v11, s[16:19], s65 offen offset:96
    buffer_load_dwordx4 v[60:63], v2, s[24:27], s64 offen offset:3072
    buffer_load_dwordx4 v[64:67], v11, s[16:19], s65 offen offset:128
    s_add_u32 s64, s64, 4096
    buffer_load_dwordx4 v[68:71], v2, s[24:27], s64 offen offset:0
    buffer_load_dwordx4 v[72:75], v11, s[16:19], s65 offen offset:160
    buffer_load_dwordx4 v[76:79], v2, s[24:27], s64 offen offset:1024
    buffer_load_dwordx4 v[80:83], v11, s[16:19], s65 offen offset:192
    buffer_load_dwordx4 v[84:87], v2, s[24:27], s64 offen offset:2048
    buffer_load_dwordx4 v[88:91], v11, s[16:19], s65 offen offset:224
    buffer_load_dwordx4 v[92:95], v2, s[24:27], s64 offen offset:3072
    s_cmp_eq_u32 s61, 0
    s_cbranch_scc0 L_k2_attn_kernel_nob2
    s_mov_b32 s61, 1
    s_barrier
L_k2_attn_kernel_nob2:
    s_cmp_eq_u32 s62, s66
    s_cselect_b32 s68, 1, 0
    s_cmp_eq_u32 s60, 0
    s_cselect_b32 s69, s63, 0
    s_cmp_eq_u32 s35, 3
    s_cselect_b32 s70, 1, 0
    s_cmp_eq_u32 s60, 0
    s_cselect_b32 s69, s69, s70
    s_and_b32 s68, s68, s69
    s_cmp_eq_u32 s60, 0
    s_cbranch_scc0 L_k2_attn_kernel_short
    s_xor_b32 s64, s59, 1
    s_lshl_b32 s65, s64, 8
    s_add_u32 s65, s65, s45
    s_lshl_b32 s64, s64, 13
    s_add_u32 s64, s64, s43
    buffer_load_dwordx4 v[96:99], v11, s[16:19], s65 offen offset:0
    buffer_load_dwordx4 v[100:103], v2, s[24:27], s64 offen offset:0
    buffer_load_dwordx4 v[104:107], v11, s[16:19], s65 offen offset:32
    buffer_load_dwordx4 v[108:111], v2, s[24:27], s64 offen offset:1024
    buffer_load_dwordx4 v[112:115], v11, s[16:19], s65 offen offset:64
    buffer_load_dwordx4 v[116:119], v2, s[24:27], s64 offen offset:2048
    buffer_load_dwordx4 v[120:123], v11, s[16:19], s65 offen offset:96
    buffer_load_dwordx4 v[124:127], v2, s[24:27], s64 offen offset:3072
    buffer_load_dwordx4 v[128:131], v11, s[16:19], s65 offen offset:128
    s_add_u32 s64, s64, 4096
    buffer_load_dwordx4 v[132:135], v2, s[24:27], s64 offen offset:0
    buffer_load_dwordx4 v[136:139], v11, s[16:19], s65 offen offset:160
    buffer_load_dwordx4 v[140:143], v2, s[24:27], s64 offen offset:1024
    buffer_load_dwordx4 v[144:147], v11, s[16:19], s65 offen offset:192
    buffer_load_dwordx4 v[148:151], v2, s[24:27], s64 offen offset:2048
    buffer_load_dwordx4 v[152:155], v11, s[16:19], s65 offen offset:224
    buffer_load_dwordx4 v[156:159], v2, s[24:27], s64 offen offset:3072
    s_waitcnt vmcnt(30)
    v_mfma_f32_32x32x16_bf16 v[16:31], v[36:39], v[32:35], v[16:31]
    s_waitcnt vmcnt(28)
    v_mfma_f32_32x32x16_bf16 v[16:31], v[44:47], v[40:43], v[16:31]
    s_waitcnt vmcnt(26)
    v_mfma_f32_32x32x16_bf16 v[16:31], v[52:55], v[48:51], v[16:31]
    s_waitcnt vmcnt(24)
    v_mfma_f32_32x32x16_bf16 v[16:31], v[60:63], v[56:59], v[16:31]
    s_waitcnt vmcnt(22)
    v_mfma_f32_32x32x16_bf16 v[16:31], v[68:71], v[64:67], v[16:31]
    s_waitcnt vmcnt(20)
    v_mfma_f32_32x32x16_bf16 v[16:31], v[76:79], v[72:75], v[16:31]
    s_waitcnt vmcnt(18)
    v_mfma_f32_32x32x16_bf16 v[16:31], v[84:87], v[80:83], v[16:31]
    s_waitcnt vmcnt(16)
    v_mfma_f32_32x32x16_bf16 v[16:31], v[92:95], v[88:91], v[16:31]
    s_waitcnt vmcnt(14)
    v_mfma_f32_32x32x16_bf16 v[16:31], v[100:103], v[96:99], v[16:31]
    s_waitcnt vmcnt(12)
    v_mfma_f32_32x32x16_bf16 v[16:31], v[108:111], v[104:107], v[16:31]
    s_waitcnt vmcnt(10)
    v_mfma_f32_32x32x16_bf16 v[16:31], v[116:119], v[112:115], v[16:31]
    s_waitcnt vmcnt(8)
    v_mfma_f32_32x32x16_bf16 v[16:31], v[124:127], v[120:123], v[16:31]
    s_waitcnt vmcnt(6)
    v_mfma_f32_32x32x16_bf16 v[16:31], v[132:135], v[128:131], v[16:31]
    s_waitcnt vmcnt(4)
    v_mfma_f32_32x32x16_bf16 v[16:31], v[140:143], v[136:139], v[16:31]
    s_waitcnt vmcnt(2)
    v_mfma_f32_32x32x16_bf16 v[16:31], v[148:151], v[144:147], v[16:31]
    s_waitcnt vmcnt(0)
    v_mfma_f32_32x32x16_bf16 v[16:31], v[156:159], v[152:155], v[16:31]
    s_branch L_k2_attn_kernel_mmd
L_k2_attn_kernel_short:
    s_waitcnt vmcnt(14)
    v_mfma_f32_32x32x16_bf16 v[16:31], v[36:39], v[32:35], v[16:31]
    s_waitcnt vmcnt(12)
    v_mfma_f32_32x32x16_bf16 v[16:31], v[44:47], v[40:43], v[16:31]
    s_waitcnt vmcnt(10)
    v_mfma_f32_32x32x16_bf16 v[16:31], v[52:55], v[48:51], v[16:31]
    s_waitcnt vmcnt(8)
    v_mfma_f32_32x32x16_bf16 v[16:31], v[60:63], v[56:59], v[16:31]
    s_waitcnt vmcnt(6)
    v_mfma_f32_32x32x16_bf16 v[16:31], v[68:71], v[64:67], v[16:31]
    s_waitcnt vmcnt(4)
    v_mfma_f32_32x32x16_bf16 v[16:31], v[76:79], v[72:75], v[16:31]
    s_waitcnt vmcnt(2)
    v_mfma_f32_32x32x16_bf16 v[16:31], v[84:87], v[80:83], v[16:31]
    s_waitcnt vmcnt(0)
    v_mfma_f32_32x32x16_bf16 v[16:31], v[92:95], v[88:91], v[16:31]
L_k2_attn_kernel_mmd:
    s_cmp_eq_u32 s68, 1
    s_cbranch_scc0 L_k2_attn_kernel_nox
    s_mov_b32 s45, 1024
    buffer_load_dwordx4 v[32:35], v11, s[16:19], s45 offen
    buffer_load_dwordx4 v[36:39], v2, s[24:27], s67 offen
    s_waitcnt vmcnt(0)
    v_mfma_f32_32x32x16_bf16 v[16:31], v[36:39], v[32:35], v[16:31]
L_k2_attn_kernel_nox:
    s_nop 15
    s_cmp_eq_u32 s60, 0
    s_cbranch_scc1 L_k2_attn_kernel_nospin
    v_mov_b32 v12, 147464
L_k2_attn_kernel_spin:
    ds_read_b32 v13, v12
    s_waitcnt lgkmcnt(0)
    v_readfirstlane_b32 s47, v13
    s_nop 3
    s_cmp_eq_u32 s47, 0
    s_cbranch_scc0 L_k2_attn_kernel_nospin
    s_sleep 2
    s_branch L_k2_attn_kernel_spin
L_k2_attn_kernel_nospin:
    s_lshl_b32 s45, s35, 12
    s_add_u32 s45, s45, 131072
    v_add_u32 v12, s45, v2
    ds_write_b128 v12, v[16:19] offset:0
    ds_write_b128 v12, v[20:23] offset:1024
    ds_write_b128 v12, v[24:27] offset:2048
    ds_write_b128 v12, v[28:31] offset:3072
    s_waitcnt lgkmcnt(0)
    s_lshl_b32 s45, s60, 2
    s_add_u32 s45, s45, 147456
    v_mov_b32 v12, s45
    v_mov_b32 v13, 1
    s_mov_b64 exec, 1
    ds_add_rtn_u32 v14, v12, v13
    s_waitcnt lgkmcnt(0)
    s_mov_b64 exec, -1
    v_readfirstlane_b32 s47, v14
    s_nop 3
    s_cmp_eq_u32 s47, 3
    s_cbranch_scc0 L_k2_attn_kernel_nextjob
    v_add_u32 v12, 131072, v2
    ds_read_b128 v[32:35], v12 offset:0
    ds_read_b128 v[36:39], v12 offset:1024
    ds_read_b128 v[40:43], v12 offset:2048
    ds_read_b128 v[44:47], v12 offset:3072
    ds_read_b128 v[80:83], v12 offset:4096
    ds_read_b128 v[84:87], v12 offset:5120
    ds_read_b128 v[88:91], v12 offset:6144
    ds_read_b128 v[92:95], v12 offset:7168
    ds_read_b128 v[48:51], v12 offset:8192
    ds_read_b128 v[52:55], v12 offset:9216
    ds_read_b128 v[56:59], v12 offset:10240
    ds_read_b128 v[60:63], v12 offset:11264
    s_waitcnt lgkmcnt(8)
    ds_read_b128 v[96:99], v12 offset:12288
    ds_read_b128 v[100:103], v12 offset:13312
    ds_read_b128 v[104:107], v12 offset:14336
    ds_read_b128 v[108:111], v12 offset:15360
    s_waitcnt lgkmcnt(0)
    v_mov_b32 v12, 147464
    v_mov_b32 v13, 1
    ds_write_b32 v12, v13
    v_add_f32 v48, v48, v96
    v_add_f32 v49, v49, v97
    v_add_f32 v50, v50, v98
    v_add_f32 v51, v51, v99
    v_add_f32 v52, v52, v100
    v_add_f32 v53, v53, v101
    v_add_f32 v54, v54, v102
    v_add_f32 v55, v55, v103
    v_add_f32 v56, v56, v104
    v_add_f32 v57, v57, v105
    v_add_f32 v58, v58, v106
    v_add_f32 v59, v59, v107
    v_add_f32 v60, v60, v108
    v_add_f32 v61, v61, v109
    v_add_f32 v62, v62, v110
    v_add_f32 v63, v63, v111
    v_add_f32 v32, v32, v80
    v_add_f32 v33, v33, v81
    v_add_f32 v34, v34, v82
    v_add_f32 v35, v35, v83
    v_add_f32 v36, v36, v84
    v_add_f32 v37, v37, v85
    v_add_f32 v38, v38, v86
    v_add_f32 v39, v39, v87
    v_add_f32 v40, v40, v88
    v_add_f32 v41, v41, v89
    v_add_f32 v42, v42, v90
    v_add_f32 v43, v43, v91
    v_add_f32 v44, v44, v92
    v_add_f32 v45, v45, v93
    v_add_f32 v46, v46, v94
    v_add_f32 v47, v47, v95
    s_cmp_eq_u32 s60, 0
    s_cbranch_scc1 L_k2_attn_kernel_haveq
    v_add_f32 v32, v32, v48
    v_mov_b32 v48, 0
    v_add_f32 v33, v33, v49
    v_mov_b32 v49, 0
    v_add_f32 v34, v34, v50
    v_mov_b32 v50, 0
    v_add_f32 v35, v35, v51
    v_mov_b32 v51, 0
    v_add_f32 v36, v36, v52
    v_mov_b32 v52, 0
    v_add_f32 v37, v37, v53
    v_mov_b32 v53, 0
    v_add_f32 v38, v38, v54
    v_mov_b32 v54, 0
    v_add_f32 v39, v39, v55
    v_mov_b32 v55, 0
    v_add_f32 v40, v40, v56
    v_mov_b32 v56, 0
    v_add_f32 v41, v41, v57
    v_mov_b32 v57, 0
    v_add_f32 v42, v42, v58
    v_mov_b32 v58, 0
    v_add_f32 v43, v43, v59
    v_mov_b32 v59, 0
    v_add_f32 v44, v44, v60
    v_mov_b32 v60, 0
    v_add_f32 v45, v45, v61
    v_mov_b32 v61, 0
    v_add_f32 v46, v46, v62
    v_mov_b32 v62, 0
    v_add_f32 v47, v47, v63
    v_mov_b32 v63, 0
L_k2_attn_kernel_haveq:
    v_sub_f32 v64, v32, v48
    v_add_f32 v32, v32, v48
    v_sub_f32 v65, v33, v49
    v_add_f32 v33, v33, v49
    v_sub_f32 v66, v34, v50
    v_add_f32 v34, v34, v50
    v_sub_f32 v67, v35, v51
    v_add_f32 v35, v35, v51
    v_sub_f32 v68, v36, v52
    v_add_f32 v36, v36, v52
    v_sub_f32 v69, v37, v53
    v_add_f32 v37, v37, v53
    v_sub_f32 v70, v38, v54
    v_add_f32 v38, v38, v54
    v_sub_f32 v71, v39, v55
    v_add_f32 v39, v39, v55
    v_sub_f32 v72, v40, v56
    v_add_f32 v40, v40, v56
    v_sub_f32 v73, v41, v57
    v_add_f32 v41, v41, v57
    v_sub_f32 v74, v42, v58
    v_add_f32 v42, v42, v58
    v_sub_f32 v75, v43, v59
    v_add_f32 v43, v43, v59
    v_sub_f32 v76, v44, v60
    v_add_f32 v44, v44, v60
    v_sub_f32 v77, v45, v61
    v_add_f32 v45, v45, v61
    v_sub_f32 v78, v46, v62
    v_add_f32 v46, v46, v62
    v_sub_f32 v79, v47, v63
    v_add_f32 v47, v47, v63
    v_cvt_pk_bf16_f32 v80, v64, v65
    v_cvt_pk_bf16_f32 v88, v32, v33
    v_cvt_pk_bf16_f32 v81, v66, v67
    v_cvt_pk_bf16_f32 v89, v34, v35
    v_cvt_pk_bf16_f32 v82, v68, v69
    v_cvt_pk_bf16_f32 v90, v36, v37
    v_cvt_pk_bf16_f32 v83, v70, v71
    v_cvt_pk_bf16_f32 v91, v38, v39
    v_cvt_pk_bf16_f32 v84, v72, v73
    v_cvt_pk_bf16_f32 v92, v40, v41
    v_cvt_pk_bf16_f32 v85, v74, v75
    v_cvt_pk_bf16_f32 v93, v42, v43
    v_cvt_pk_bf16_f32 v86, v76, v77
    v_cvt_pk_bf16_f32 v94, v44, v45
    v_cvt_pk_bf16_f32 v87, v78, v79
    v_cvt_pk_bf16_f32 v95, v46, v47
    v_mul_u32_u24 v13, 576, v8
    v_lshl_add_u32 v13, v10, 3, v13
    s_lshl_b32 s42, s41, 6
    s_add_u32 s42, s42, 8388608
    s_add_u32 s43, s42, 0x100000
    buffer_store_dwordx2 v[80:81], v13, s[24:27], s42 offen offset:0 sc1
    buffer_store_dwordx2 v[88:89], v13, s[24:27], s43 offen offset:0 sc1
    buffer_store_dwordx2 v[82:83], v13, s[24:27], s42 offen offset:16 sc1
    buffer_store_dwordx2 v[90:91], v13, s[24:27], s43 offen offset:16 sc1
    buffer_store_dwordx2 v[84:85], v13, s[24:27], s42 offen offset:32 sc1
    buffer_store_dwordx2 v[92:93], v13, s[24:27], s43 offen offset:32 sc1
    buffer_store_dwordx2 v[86:87], v13, s[24:27], s42 offen offset:48 sc1
    buffer_store_dwordx2 v[94:95], v13, s[24:27], s43 offen offset:48 sc1
    s_waitcnt vmcnt(0)
    v_lshlrev_b32 v12, 7, v1
    v_add_u32 v12, 13107204, v12
    v_mov_b32 v13, 1
    s_mov_b64 exec, 0xff
    global_atomic_add v12, v13, s[24:25] sc1
    s_mov_b64 exec, -1
L_k2_attn_kernel_nextjob:
    s_add_u32 s60, s60, 1
    s_cmp_eq_u32 s60, 1
    s_cbranch_scc0 L_k2_attn_kernel_fin
    s_cmp_ge_u32 s2, 224
    s_cbranch_scc1 L_k2_attn_kernel_edgec
    s_sub_u32 s42, s2, 192
    s_cmp_lt_u32 s42, 9
    s_cbranch_scc0 L_k2_attn_kernel_fin
    s_mov_b32 s40, 32
    s_mov_b32 s41, s42
    s_branch L_k2_attn_kernel_job
L_k2_attn_kernel_edgec:
    s_mov_b32 s41, 8
    s_branch L_k2_attn_kernel_job
L_k2_attn_kernel_fin:
    s_setprio 0
    s_mov_b32 s8, s56
    s_mov_b32 s9, s57
    s_mov_b32 s10, 0x80000
    s_mov_b32 s11, 0x20000
    v_lshrrev_b32 v3, 3, v1
    v_bfe_u32 v4, v1, 4, 1
    v_lshlrev_b32 v4, 2, v4
    v_and_b32 v5, 7, v1
    v_xor_b32 v4, v4, v5
    v_lshlrev_b32 v4, 4, v4
    v_lshl_add_u32 v3, v3, 10, v4
    s_lshl_b32 s45, s35, 17
    s_lshr_b32 s48, s2, 5
    s_lshl_b32 s48, s48, 7
    s_add_u32 s45, s45, s48
    s_add_u32 s49, s45, 0
    buffer_load_dwordx4 v[32:35], v3, s[8:11], s49 offen
    s_add_u32 s49, s45, 8192
    buffer_load_dwordx4 v[36:39], v3, s[8:11], s49 offen
    s_add_u32 s49, s45, 16384
    buffer_load_dwordx4 v[40:43], v3, s[8:11], s49 offen
    s_add_u32 s49, s45, 24576
    buffer_load_dwordx4 v[44:47], v3, s[8:11], s49 offen
    s_add_u32 s49, s45, 32768
    buffer_load_dwordx4 v[48:51], v3, s[8:11], s49 offen
    s_add_u32 s49, s45, 40960
    buffer_load_dwordx4 v[52:55], v3, s[8:11], s49 offen
    s_add_u32 s49, s45, 49152
    buffer_load_dwordx4 v[56:59], v3, s[8:11], s49 offen
    s_add_u32 s49, s45, 57344
    buffer_load_dwordx4 v[60:63], v3, s[8:11], s49 offen
    s_add_u32 s49, s45, 65536
    buffer_load_dwordx4 v[64:67], v3, s[8:11], s49 offen
    s_add_u32 s49, s45, 73728
    buffer_load_dwordx4 v[68:71], v3, s[8:11], s49 offen
    s_add_u32 s49, s45, 81920
    buffer_load_dwordx4 v[72:75], v3, s[8:11], s49 offen
    s_add_u32 s49, s45, 90112
    buffer_load_dwordx4 v[76:79], v3, s[8:11], s49 offen
    s_add_u32 s49, s45, 98304
    buffer_load_dwordx4 v[80:83], v3, s[8:11], s49 offen
    s_add_u32 s49, s45, 106496
    buffer_load_dwordx4 v[84:87], v3, s[8:11], s49 offen
    s_add_u32 s49, s45, 114688
    buffer_load_dwordx4 v[88:91], v3, s[8:11], s49 offen
    s_add_u32 s49, s45, 122880
    buffer_load_dwordx4 v[92:95], v3, s[8:11], s49 offen
    s_lshl_b32 s45, s35, 14
    v_add_u32 v4, s45, v2
    s_waitcnt vmcnt(0)
    s_barrier
    ds_write_b128 v4, v[32:35] offset:0
    ds_write_b128 v4, v[36:39] offset:1024
    ds_write_b128 v4, v[40:43] offset:2048
    ds_write_b128 v4, v[44:47] offset:3072
    ds_write_b128 v4, v[48:51] offset:4096
    ds_write_b128 v4, v[52:55] offset:5120
    ds_write_b128 v4, v[56:59] offset:6144
    ds_write_b128 v4, v[60:63] offset:7168
    ds_write_b128 v4, v[64:67] offset:8192
    ds_write_b128 v4, v[68:71] offset:9216
    ds_write_b128 v4, v[72:75] offset:10240
    ds_write_b128 v4, v[76:79] offset:11264
    ds_write_b128 v4, v[80:83] offset:12288
    ds_write_b128 v4, v[84:87] offset:13312
    ds_write_b128 v4, v[88:91] offset:14336
    ds_write_b128 v4, v[92:95] offset:15360
    s_waitcnt lgkmcnt(0)
    s_barrier
    s_branch L_k2_attn_kernel_end
L_k2_attn_kernel_endB:
    s_setprio 0
    s_barrier
    s_cmp_ge_u32 s32, 4
    s_cbranch_scc1 L_k2_attn_kernel_w47
    s_cmp_eq_u32 s32, 0
    s_cbranch_scc0 L_k2_attn_kernel_nosig
    s_lshr_b32 s33, s2, 5
    s_lshl_b32 s33, s33, 7
    s_add_u32 s33, s33, 13107200
    v_mov_b32 v12, s33
    v_mov_b32 v13, 1
    s_mov_b64 exec, 1
    global_atomic_add v12, v13, s[24:25] sc1
    s_mov_b64 exec, -1
L_k2_attn_kernel_nosig:
    s_and_b32 s33, s2, 7
    s_lshr_b32 s34, s2, 3
    s_and_b32 s35, s34, 3
    s_lshl_b32 s40, s33, 2
    s_add_u32 s40, s40, s35
    s_lshr_b32 s41, s2, 5
    s_and_b32 s42, s32, 1
    s_lshr_b32 s43, s32, 1
    s_lshl_b32 s44, s40, 1
    s_add_u32 s44, s44, s42
    s_mov_b32 s12, s72
    s_mov_b32 s13, s73
    s_mov_b32 s14, 0x200000
    s_mov_b32 s15, 0x20000
    v_and_b32 v8, 31, v1
    v_lshrrev_b32 v9, 5, v1
    s_lshl_b32 s58, s44, 5
    v_add_u32 v10, s58, v8
    v_and_b32 v12, 511, v10
    s_lshr_b32 s58, s44, 4
    s_cmp_eq_u32 s58, 0
    s_cselect_b32 s59, 0, 1024
    s_cmp_eq_u32 s58, 1
    s_cselect_b32 s59, 2048, s59
    s_and_b32 s61, s58, 1
    s_cmp_eq_u32 s58, 1
    s_cselect_b32 s62, 1, 0
    s_cmp_eq_u32 s58, 2
    s_cselect_b32 s62, 1, s62
    v_add_u32 v10, s59, v12
    v_sub_u32 v11, s59, v12
    s_cmp_eq_u32 s62, 1
    s_cselect_b64 vcc, -1, 0
    v_cndmask_b32 v10, v10, v11, vcc
    s_cmp_lt_u32 s58, 2
    s_cselect_b64 vcc, -1, 0
    v_sub_u32 v11, 1024, v12
    v_cndmask_b32 v13, v11, v12, vcc
    s_lshl_b32 s61, s61, 20
    v_mov_b32 v106, s61
    s_lshr_b32 s62, s58, 1
    s_lshl_b32 s63, s62, 10
    s_add_u32 s63, s63, 512
    s_lshl_b32 s62, s62, 20
    s_and_b32 s59, s58, 1
    s_cmp_eq_u32 s59, 1
    s_cselect_b64 s[64:65], -1, 0
    v_cmp_eq_u32 vcc, 0, v12
    s_nop 1
    s_and_b64 vcc, vcc, s[64:65]
    v_mov_b32 v11, s63
    v_cndmask_b32 v10, v10, v11, vcc
    v_mov_b32 v11, 512
    v_cndmask_b32 v13, v13, v11, vcc
    v_mov_b32 v11, s62
    v_cndmask_b32 v106, v106, v11, vcc
    v_lshlrev_b32 v11, 10, v10
    v_lshl_add_u32 v11, v9, 3, v11
    s_lshl_b32 s58, s41, 7
    s_lshl_b32 s59, s43, 6
    s_add_u32 s58, s58, s59
    v_add_u32 v11, s58, v11
    v_mul_u32_u24 v13, 576, v13
    v_lshlrev_b32 v12, 3, v9
    s_cmp_lt_u32 s41, 4
    s_cbranch_scc0 L_k2_attn_kernel_ym
    v_add_u32 v13, v13, v12
    v_add_u32 v13, s58, v13
    s_branch L_k2_attn_kernel_ymd
L_k2_attn_kernel_ym:
    v_sub_u32 v13, v13, v12
    s_sub_u32 s59, 1018-48, s58
    v_add_u32 v13, s59, v13
L_k2_attn_kernel_ymd:
    s_lshr_b32 s59, s41, 2
    s_lshl_b32 s59, s59, 20
    v_xor_b32 v106, s59, v106
    v_add_u32 v13, v13, v106
    s_mov_b32 s60, 8388608
    v_lshlrev_b32 v105, 2, v10
    v_bfe_u32 v5, v1, 2, 2
    v_lshl_add_u32 v6, v9, 2, v5
    v_lshlrev_b32 v6, 7, v6
    v_bfe_u32 v7, v1, 3, 1
    v_lshlrev_b32 v7, 6, v7
    v_bfe_u32 v16, v1, 4, 1
    v_lshl_add_u32 v6, v16, 5, v6
    v_bfe_u32 v16, v1, 1, 1
    v_lshl_add_u32 v6, v16, 4, v6
    v_and_b32 v16, 1, v1
    v_lshl_add_u32 v6, v16, 3, v6
    v_add_u32 v14, v6, v7
    s_lshl_b32 s58, s43, 15
    v_add_u32 v14, s58, v14
    v_xor_b32 v15, 64, v14
    s_mov_b32 s59, 12582912
    buffer_load_dword v104, v105, s[24:27], s59 offen
    s_cmp_eq_u32 s32, 0
    s_cbranch_scc0 L_k2_attn_kernel_nopoll
    s_lshl_b32 s58, s33, 7
    s_add_u32 s58, s58, 13107200
    v_lshlrev_b32 v16, 2, v1
    v_add_u32 v16, s58, v16
    v_mov_b32 v17, 32
    v_mov_b32 v19, 297
    v_cmp_eq_u32 vcc, 1, v1
    s_nop 1
    v_cndmask_b32 v17, v17, v19, vcc
    s_mov_b32 s61, 0
    s_mov_b64 exec, 3
L_k2_attn_kernel_c_poll:
    global_load_dword v18, v16, s[24:25] sc1
    s_waitcnt vmcnt(0)
    v_cmp_eq_u32 vcc, v18, v17
    s_add_u32 s61, s61, 1
    s_nop 2
    s_cmp_eq_u64 vcc, exec
    s_cbranch_scc1 L_k2_attn_kernel_c_polld
    s_cmp_ge_u32 s61, 400000
    s_cbranch_scc1 L_k2_attn_kernel_c_polld
    s_sleep 2
    s_branch L_k2_attn_kernel_c_poll
L_k2_attn_kernel_c_polld:
    s_mov_b64 exec, -1
L_k2_attn_kernel_nopoll:
    s_barrier
    s_lshl_b32 s51, s44, 15
    s_lshl_b32 s52, s43, 14
    s_add_u32 s51, s51, s52
    s_add_u32 s51, s51, 6291456
    buffer_load_dwordx4 v[32:35], v2, s[24:27], s51 offen offset:0 sc1
    buffer_load_dwordx4 v[36:39], v2, s[24:27], s51 offen offset:1024 sc1
    buffer_load_dwordx4 v[40:43], v2, s[24:27], s51 offen offset:2048 sc1
    buffer_load_dwordx4 v[44:47], v2, s[24:27], s51 offen offset:3072 sc1
    s_add_u32 s51, s51, 4096
    buffer_load_dwordx4 v[48:51], v2, s[24:27], s51 offen offset:0 sc1
    buffer_load_dwordx4 v[52:55], v2, s[24:27], s51 offen offset:1024 sc1
    buffer_load_dwordx4 v[56:59], v2, s[24:27], s51 offen offset:2048 sc1
    buffer_load_dwordx4 v[60:63], v2, s[24:27], s51 offen offset:3072 sc1
    s_add_u32 s51, s51, 4096
    buffer_load_dwordx4 v[64:67], v2, s[24:27], s51 offen offset:0 sc1
    buffer_load_dwordx4 v[68:71], v2, s[24:27], s51 offen offset:1024 sc1
    buffer_load_dwordx4 v[72:75], v2, s[24:27], s51 offen offset:2048 sc1
    buffer_load_dwordx4 v[76:79], v2, s[24:27], s51 offen offset:3072 sc1
    s_add_u32 s51, s51, 4096
    buffer_load_dwordx4 v[80:83], v2, s[24:27], s51 offen offset:0 sc1
    buffer_load_dwordx4 v[84:87], v2, s[24:27], s51 offen offset:1024 sc1
    buffer_load_dwordx4 v[88:91], v2, s[24:27], s51 offen offset:2048 sc1
    buffer_load_dwordx4 v[92:95], v2, s[24:27], s51 offen offset:3072 sc1
    buffer_load_dwordx2 v[96:97], v13, s[24:27], s60 offen offset:0 sc1
    buffer_load_dwordx2 v[98:99], v13, s[24:27], s60 offen offset:16 sc1
    buffer_load_dwordx2 v[100:101], v13, s[24:27], s60 offen offset:32 sc1
    buffer_load_dwordx2 v[102:103], v13, s[24:27], s60 offen offset:48 sc1
    ds_read_b64_tr_b16 v[128:129], v14 offset:0
    ds_read_b64_tr_b16 v[130:131], v14 offset:1024
    ds_read_b64_tr_b16 v[132:133], v15 offset:0
    ds_read_b64_tr_b16 v[134:135], v15 offset:1024
    ds_read_b64_tr_b16 v[136:137], v14 offset:2048
    ds_read_b64_tr_b16 v[138:139], v14 offset:3072
    ds_read_b64_tr_b16 v[140:141], v15 offset:2048
    ds_read_b64_tr_b16 v[142:143], v15 offset:3072
    s_waitcnt vmcnt(19) lgkmcnt(4)
    v_mfma_f32_32x32x16_bf16 v[16:31], v[128:131], v[32:35], 0
    v_mfma_f32_32x32x16_bf16 v[112:127], v[132:135], v[32:35], 0
    ds_read_b64_tr_b16 v[128:129], v14 offset:4096
    ds_read_b64_tr_b16 v[130:131], v14 offset:5120
    ds_read_b64_tr_b16 v[132:133], v15 offset:4096
    ds_read_b64_tr_b16 v[134:135], v15 offset:5120
    s_waitcnt vmcnt(18) lgkmcnt(4)
    v_mfma_f32_32x32x16_bf16 v[16:31], v[136:139], v[36:39], v[16:31]
    v_mfma_f32_32x32x16_bf16 v[112:127], v[140:143], v[36:39], v[112:127]
    ds_read_b64_tr_b16 v[136:137], v14 offset:6144
    ds_read_b64_tr_b16 v[138:139], v14 offset:7168
    ds_read_b64_tr_b16 v[140:141], v15 offset:6144
    ds_read_b64_tr_b16 v[142:143], v15 offset:7168
    s_waitcnt vmcnt(17) lgkmcnt(4)
    v_mfma_f32_32x32x16_bf16 v[16:31], v[128:131], v[40:43], v[16:31]
    v_mfma_f32_32x32x16_bf16 v[112:127], v[132:135], v[40:43], v[112:127]
    ds_read_b64_tr_b16 v[128:129], v14 offset:8192
    ds_read_b64_tr_b16 v[130:131], v14 offset:9216
    ds_read_b64_tr_b16 v[132:133], v15 offset:8192
    ds_read_b64_tr_b16 v[134:135], v15 offset:9216
    s_waitcnt vmcnt(16) lgkmcnt(4)
    v_mfma_f32_32x32x16_bf16 v[16:31], v[136:139], v[44:47], v[16:31]
    v_mfma_f32_32x32x16_bf16 v[112:127], v[140:143], v[44:47], v[112:127]
    ds_read_b64_tr_b16 v[136:137], v14 offset:10240
    ds_read_b64_tr_b16 v[138:139], v14 offset:11264
    ds_read_b64_tr_b16 v[140:141], v15 offset:10240
    ds_read_b64_tr_b16 v[142:143], v15 offset:11264
    s_waitcnt vmcnt(15) lgkmcnt(4)
    v_mfma_f32_32x32x16_bf16 v[16:31], v[128:131], v[48:51], v[16:31]
    v_mfma_f32_32x32x16_bf16 v[112:127], v[132:135], v[48:51], v[112:127]
    ds_read_b64_tr_b16 v[128:129], v14 offset:12288
    ds_read_b64_tr_b16 v[130:131], v14 offset:13312
    ds_read_b64_tr_b16 v[132:133], v15 offset:12288
    ds_read_b64_tr_b16 v[134:135], v15 offset:13312
    s_waitcnt vmcnt(14) lgkmcnt(4)
    v_mfma_f32_32x32x16_bf16 v[16:31], v[136:139], v[52:55], v[16:31]
    v_mfma_f32_32x32x16_bf16 v[112:127], v[140:143], v[52:55], v[112:127]
    ds_read_b64_tr_b16 v[136:137], v14 offset:14336
    ds_read_b64_tr_b16 v[138:139], v14 offset:15360
    ds_read_b64_tr_b16 v[140:141], v15 offset:14336
    ds_read_b64_tr_b16 v[142:143], v15 offset:15360
    s_waitcnt vmcnt(13) lgkmcnt(4)
    v_mfma_f32_32x32x16_bf16 v[16:31], v[128:131], v[56:59], v[16:31]
    v_mfma_f32_32x32x16_bf16 v[112:127], v[132:135], v[56:59], v[112:127]
    ds_read_b64_tr_b16 v[128:129], v14 offset:16384
    ds_read_b64_tr_b16 v[130:131], v14 offset:17408
    ds_read_b64_tr_b16 v[132:133], v15 offset:16384
    ds_read_b64_tr_b16 v[134:135], v15 offset:17408
    s_waitcnt vmcnt(12) lgkmcnt(4)
    v_mfma_f32_32x32x16_bf16 v[16:31], v[136:139], v[60:63], v[16:31]
    v_mfma_f32_32x32x16_bf16 v[112:127], v[140:143], v[60:63], v[112:127]
    ds_read_b64_tr_b16 v[136:137], v14 offset:18432
    ds_read_b64_tr_b16 v[138:139], v14 offset:19456
    ds_read_b64_tr_b16 v[140:141], v15 offset:18432
    ds_read_b64_tr_b16 v[142:143], v15 offset:19456
    s_waitcnt vmcnt(11) lgkmcnt(4)
    v_mfma_f32_32x32x16_bf16 v[16:31], v[128:131], v[64:67], v[16:31]
    v_mfma_f32_32x32x16_bf16 v[112:127], v[132:135], v[64:67], v[112:127]
    ds_read_b64_tr_b16 v[128:129], v14 offset:20480
    ds_read_b64_tr_b16 v[130:131], v14 offset:21504
    ds_read_b64_tr_b16 v[132:133], v15 offset:20480
    ds_read_b64_tr_b16 v[134:135], v15 offset:21504
    s_waitcnt vmcnt(10) lgkmcnt(4)
    v_mfma_f32_32x32x16_bf16 v[16:31], v[136:139], v[68:71], v[16:31]
    v_mfma_f32_32x32x16_bf16 v[112:127], v[140:143], v[68:71], v[112:127]
    ds_read_b64_tr_b16 v[136:137], v14 offset:22528
    ds_read_b64_tr_b16 v[138:139], v14 offset:23552
    ds_read_b64_tr_b16 v[140:141], v15 offset:22528
    ds_read_b64_tr_b16 v[142:143], v15 offset:23552
    s_waitcnt vmcnt(9) lgkmcnt(4)
    v_mfma_f32_32x32x16_bf16 v[16:31], v[128:131], v[72:75], v[16:31]
    v_mfma_f32_32x32x16_bf16 v[112:127], v[132:135], v[72:75], v[112:127]
    ds_read_b64_tr_b16 v[128:129], v14 offset:24576
    ds_read_b64_tr_b16 v[130:131], v14 offset:25600
    ds_read_b64_tr_b16 v[132:133], v15 offset:24576
    ds_read_b64_tr_b16 v[134:135], v15 offset:25600
    s_waitcnt vmcnt(8) lgkmcnt(4)
    v_mfma_f32_32x32x16_bf16 v[16:31], v[136:139], v[76:79], v[16:31]
    v_mfma_f32_32x32x16_bf16 v[112:127], v[140:143], v[76:79], v[112:127]
    ds_read_b64_tr_b16 v[136:137], v14 offset:26624
    ds_read_b64_tr_b16 v[138:139], v14 offset:27648
    ds_read_b64_tr_b16 v[140:141], v15 offset:26624
    ds_read_b64_tr_b16 v[142:143], v15 offset:27648
    s_waitcnt vmcnt(7) lgkmcnt(4)
    v_mfma_f32_32x32x16_bf16 v[16:31], v[128:131], v[80:83], v[16:31]
    v_mfma_f32_32x32x16_bf16 v[112:127], v[132:135], v[80:83], v[112:127]
    ds_read_b64_tr_b16 v[128:129], v14 offset:28672
    ds_read_b64_tr_b16 v[130:131], v14 offset:29696
    ds_read_b64_tr_b16 v[132:133], v15 offset:28672
    ds_read_b64_tr_b16 v[134:135], v15 offset:29696
    s_waitcnt vmcnt(6) lgkmcnt(4)
    v_mfma_f32_32x32x16_bf16 v[16:31], v[136:139], v[84:87], v[16:31]
    v_mfma_f32_32x32x16_bf16 v[112:127], v[140:143], v[84:87], v[112:127]
    ds_read_b64_tr_b16 v[136:137], v14 offset:30720
    ds_read_b64_tr_b16 v[138:139], v14 offset:31744
    ds_read_b64_tr_b16 v[140:141], v15 offset:30720
    ds_read_b64_tr_b16 v[142:143], v15 offset:31744
    s_waitcnt vmcnt(5) lgkmcnt(4)
    v_mfma_f32_32x32x16_bf16 v[16:31], v[128:131], v[88:91], v[16:31]
    v_mfma_f32_32x32x16_bf16 v[112:127], v[132:135], v[88:91], v[112:127]
    s_waitcnt vmcnt(4) lgkmcnt(0)
    v_mfma_f32_32x32x16_bf16 v[16:31], v[136:139], v[92:95], v[16:31]
    v_mfma_f32_32x32x16_bf16 v[112:127], v[140:143], v[92:95], v[112:127]
    s_lshl_b32 s48, s42, 13
    s_xor_b32 s49, s43, 1
    s_lshl_b32 s49, s49, 12
    s_add_u32 s49, s49, s48
    s_add_u32 s49, s49, 65536
    v_add_u32 v5, s49, v2
    s_lshl_b32 s49, s43, 12
    s_add_u32 s49, s49, s48
    s_add_u32 s49, s49, 65536
    v_add_u32 v6, s49, v2
    s_nop 7
    s_cmp_eq_u32 s43, 0
    s_cbranch_scc0 L_k2_attn_kernel_kw1
    ds_write_b128 v5, v[112:115] offset:0
    ds_write_b128 v5, v[116:119] offset:1024
    ds_write_b128 v5, v[120:123] offset:2048
    ds_write_b128 v5, v[124:127] offset:3072
    s_branch L_k2_attn_kernel_x
L_k2_attn_kernel_kw1:
    ds_write_b128 v5, v[16:19] offset:0
    ds_write_b128 v5, v[20:23] offset:1024
    ds_write_b128 v5, v[24:27] offset:2048
    ds_write_b128 v5, v[28:31] offset:3072
    s_nop 1
    v_mov_b32 v16, v112
    v_mov_b32 v17, v113
    v_mov_b32 v18, v114
    v_mov_b32 v19, v115
    v_mov_b32 v20, v116
    v_mov_b32 v21, v117
    v_mov_b32 v22, v118
    v_mov_b32 v23, v119
    v_mov_b32 v24, v120
    v_mov_b32 v25, v121
    v_mov_b32 v26, v122
    v_mov_b32 v27, v123
    v_mov_b32 v28, v124
    v_mov_b32 v29, v125
    v_mov_b32 v30, v126
    v_mov_b32 v31, v127
L_k2_attn_kernel_x:
    s_waitcnt vmcnt(0) lgkmcnt(0)
    s_barrier
    ds_read_b128 v[32:35], v6 offset:0
    ds_read_b128 v[36:39], v6 offset:1024
    ds_read_b128 v[40:43], v6 offset:2048
    ds_read_b128 v[44:47], v6 offset:3072
    v_sub_f32 v105, 1.0, v104
    s_cmp_lt_u32 s41, 4
    s_cbranch_scc0 L_k2_attn_kernel_um
    v_lshlrev_b32 v48, 16, v96
    v_and_b32 v49, 0xffff0000, v96
    v_lshlrev_b32 v50, 16, v97
    v_and_b32 v51, 0xffff0000, v97
    v_lshlrev_b32 v52, 16, v98
    v_and_b32 v53, 0xffff0000, v98
    v_lshlrev_b32 v54, 16, v99
    v_and_b32 v55, 0xffff0000, v99
    v_lshlrev_b32 v56, 16, v100
    v_and_b32 v57, 0xffff0000, v100
    v_lshlrev_b32 v58, 16, v101
    v_and_b32 v59, 0xffff0000, v101
    v_lshlrev_b32 v60, 16, v102
    v_and_b32 v61, 0xffff0000, v102
    v_lshlrev_b32 v62, 16, v103
    v_and_b32 v63, 0xffff0000, v103
    s_branch L_k2_attn_kernel_umd
L_k2_attn_kernel_um:
    v_and_b32 v60, 0xffff0000, v97
    v_lshlrev_b32 v61, 16, v97
    v_and_b32 v62, 0xffff0000, v96
    v_lshlrev_b32 v63, 16, v96
    v_and_b32 v56, 0xffff0000, v99
    v_lshlrev_b32 v57, 16, v99
    v_and_b32 v58, 0xffff0000, v98
    v_lshlrev_b32 v59, 16, v98
    v_and_b32 v52, 0xffff0000, v101
    v_lshlrev_b32 v53, 16, v101
    v_and_b32 v54, 0xffff0000, v100
    v_lshlrev_b32 v55, 16, v100
    v_and_b32 v48, 0xffff0000, v103
    v_lshlrev_b32 v49, 16, v103
    v_and_b32 v50, 0xffff0000, v102
    v_lshlrev_b32 v51, 16, v102
L_k2_attn_kernel_umd:
    v_mul_f32 v48, v104, v48
    v_mul_f32 v49, v104, v49
    v_mul_f32 v50, v104, v50
    v_mul_f32 v51, v104, v51
    v_mul_f32 v52, v104, v52
    v_mul_f32 v53, v104, v53
    v_mul_f32 v54, v104, v54
    v_mul_f32 v55, v104, v55
    v_mul_f32 v56, v104, v56
    v_mul_f32 v57, v104, v57
    v_mul_f32 v58, v104, v58
    v_mul_f32 v59, v104, v59
    v_mul_f32 v60, v104, v60
    v_mul_f32 v61, v104, v61
    v_mul_f32 v62, v104, v62
    v_mul_f32 v63, v104, v63
    s_waitcnt lgkmcnt(0)
    v_add_f32 v16, v16, v32
    v_add_f32 v17, v17, v33
    v_add_f32 v18, v18, v34
    v_add_f32 v19, v19, v35
    v_add_f32 v20, v20, v36
    v_add_f32 v21, v21, v37
    v_add_f32 v22, v22, v38
    v_add_f32 v23, v23, v39
    v_add_f32 v24, v24, v40
    v_add_f32 v25, v25, v41
    v_add_f32 v26, v26, v42
    v_add_f32 v27, v27, v43
    v_add_f32 v28, v28, v44
    v_add_f32 v29, v29, v45
    v_add_f32 v30, v30, v46
    v_add_f32 v31, v31, v47
    v_fmac_f32 v48, v105, v16
    v_fmac_f32 v49, v105, v17
    v_fmac_f32 v50, v105, v18
    v_fmac_f32 v51, v105, v19
    v_fmac_f32 v52, v105, v20
    v_fmac_f32 v53, v105, v21
    v_fmac_f32 v54, v105, v22
    v_fmac_f32 v55, v105, v23
    v_fmac_f32 v56, v105, v24
    v_fmac_f32 v57, v105, v25
    v_fmac_f32 v58, v105, v26
    v_fmac_f32 v59, v105, v27
    v_fmac_f32 v60, v105, v28
    v_fmac_f32 v61, v105, v29
    v_fmac_f32 v62, v105, v30
    v_fmac_f32 v63, v105, v31
    v_cvt_pk_bf16_f32 v64, v48, v49
    v_cvt_pk_bf16_f32 v65, v50, v51
    v_cvt_pk_bf16_f32 v66, v52, v53
    v_cvt_pk_bf16_f32 v67, v54, v55
    v_cvt_pk_bf16_f32 v68, v56, v57
    v_cvt_pk_bf16_f32 v69, v58, v59
    v_cvt_pk_bf16_f32 v70, v60, v61
    v_cvt_pk_bf16_f32 v71, v62, v63
    v_lshl_add_u32 v11, v9, 3, v11
    v_permlane32_swap_b32 v64, v66
    v_permlane32_swap_b32 v65, v67
    v_permlane32_swap_b32 v68, v70
    v_permlane32_swap_b32 v69, v71
    buffer_store_dwordx4 v[64:67], v11, s[12:15], 0 offen offset:0
    buffer_store_dwordx4 v[68:71], v11, s[12:15], 0 offen offset:32
    s_branch L_k2_attn_kernel_end
L_k2_attn_kernel_w47:
    s_barrier
L_k2_attn_kernel_end:
    s_endpgm
.section .rodata,"a"
.p2align 6
.amdhsa_kernel k1_qkv_kernel
  .amdhsa_next_free_vgpr 176
  .amdhsa_next_free_sgpr 102
  .amdhsa_accum_offset 176
  .amdhsa_group_segment_fixed_size 0
  .amdhsa_kernarg_size 96
  .amdhsa_user_sgpr_count 2
  .amdhsa_user_sgpr_kernarg_segment_ptr 1
  .amdhsa_system_sgpr_workgroup_id_x 1
.end_amdhsa_kernel
.p2align 6
.amdhsa_kernel k2_attn_kernel
  .amdhsa_next_free_vgpr 168
  .amdhsa_next_free_sgpr 102
  .amdhsa_accum_offset 168
  .amdhsa_group_segment_fixed_size 0
  .amdhsa_kernarg_size 96
  .amdhsa_user_sgpr_count 2
  .amdhsa_user_sgpr_kernarg_segment_ptr 1
  .amdhsa_system_sgpr_workgroup_id_x 1
.end_amdhsa_kernel
```
